```python
import torch

def _softmax(x, axis=-1):
    return torch.softmax(x, dim=axis)
def _gelu(x):
    return torch.nn.functional.gelu(x, approximate="tanh")
def _silu(x):
    return torch.nn.functional.silu(x)
def _sigmoid(x):
    return torch.sigmoid(x)
def _layernorm(x, axis=-1, eps=1e-5):
    m = x.mean(dim=axis, keepdim=True)
    v = x.var(dim=axis, keepdim=True, unbiased=False)
    return (x - m) / torch.sqrt(v + eps)
def _scatter_add(tgt, idx, src, axis=0):
    return tgt.clone().index_add_(axis, idx, src)
def _segment_sum(src, seg, n):
    out = torch.zeros((n,) + src.shape[1:], dtype=src.dtype)
    return out.index_add_(0, seg, src)
def _pad(x, pw):
    flat = tuple(v for pair in reversed(pw) for v in pair)
    return torch.nn.functional.pad(x, flat)

kernel_name = 'gated_mix__ssm_conv_h3__mixer_s_mlp__prompt'

def setup_inputs():

    _w = (lambda a: (lambda t: t.to(torch.bfloat16) if t.is_floating_point() else t)(torch.as_tensor(a)))
    def _A_setup():
        B, S, D = 1, 2048, 576
        ks = 4
        return {
            "q": _w((lambda *s: torch.randn(*s, dtype=torch.bfloat16) * 0.05)(B, S, D)),
            "k": _w((lambda *s: torch.randn(*s, dtype=torch.bfloat16) * 1.6)(B, S, D)),
            "v": _w((lambda *s: torch.randn(*s, dtype=torch.bfloat16) * 1.6)(B, S, D)),
            "shift_k": _w((lambda *s: torch.randn(*s, dtype=torch.bfloat16) * 1.6)(D, ks) * 0.5),
            "ssm_k": _w((lambda *s: torch.randn(*s, dtype=torch.bfloat16) * 3.2)(D, S) * (1.0 / S ** 0.5)),
            "ssm_D": _w((lambda *s: torch.randn(*s, dtype=torch.bfloat16) * 1.6)(D)),
        }
    _A_in = _A_setup()

    def _B_setup():
        B, S, D, F = 1, 2048, 576, 4608
        return {
            "x":  _w((lambda *s: torch.randn(*s, dtype=torch.bfloat16) * 0.05)(B, S, D)),
            "w1": _w((lambda *s: torch.randn(*s, dtype=torch.bfloat16) * 3.2)(D, D) * (D ** -0.5)),
            "w2": _w((lambda *s: torch.randn(*s, dtype=torch.bfloat16) * 3.2)(D, D) * (D ** -0.5)),
            "w3": _w((lambda *s: torch.randn(*s, dtype=torch.bfloat16) * 3.2)(D, F) * (D ** -0.5)),
            "w4": _w((lambda *s: torch.randn(*s, dtype=torch.bfloat16) * 1.6)(F, D) * (F ** -0.5)),
        }
    _B_in = _B_setup()

    return {
        "A_q": _A_in["q"],
        "A_k": _A_in["k"],
        "A_v": _A_in["v"],
        "A_shift_k": _A_in["shift_k"],
        "A_ssm_k": _A_in["ssm_k"],
        "A_ssm_D": _A_in["ssm_D"],
        "B_x": _B_in["x"],
        "B_w1": _B_in["w1"],
        "B_w2": _B_in["w2"],
        "B_w3": _B_in["w3"],
        "B_w4": _B_in["w4"],
        "gate_w": _w((lambda *s: torch.randn(*s, dtype=torch.bfloat16) * 0.05)(576) * 16.0),
    }

def reference(A_q, A_k, A_v, A_shift_k, A_ssm_k, A_ssm_D, B_x, B_w1, B_w2, B_w3, B_w4, gate_w):
    def _A_ref(q, k, v, shift_k, ssm_k, ssm_D):
        B, S, D = q.shape
        ks = shift_k.shape[-1]
        k_pad = _pad(k, ((0, 0), (ks - 1, 0), (0, 0)))
        k_shift = torch.zeros_like(k)
        for t in range(ks):
            k_shift = k_shift + k_pad[:, t:t + S, :] * shift_k[:, ks - 1 - t][None, None, :]
        kv = k_shift * v
        L = 2 * S
        kv_pad = _pad(kv, ((0, 0), (0, S), (0, 0)))
        kf_pad = _pad(ssm_k, ((0, 0), (0, S)))
        kv_f = (lambda x, axes=(-2,-1): torch.fft.rfft2(x.float(), dim=axes))(kv_pad[:, None, :, :], axes=(1, 2))
        kf_f = (lambda x, axes=(-2,-1): torch.fft.rfft2(x.float(), dim=axes))(kf_pad[:, None, :], axes=(1, 2))
        kf_f = (lambda x, *d: x.permute(*d))(kf_f, 1, 2, 0)
        y_f = kv_f * kf_f[None, :, :, :]
        y = (lambda x, s, axes=(-2,-1): torch.fft.irfft2(x, s=s, dim=axes).to(torch.bfloat16))(y_f, (1, L), axes=(1, 2))[:, 0, :S, :]
        y = y + kv * ssm_D[None, None, :]
        return q * y

    def _B_ref(x, w1, w2, w3, w4):
        B, S, D = x.shape
        h = _gelu(_layernorm(x, axis=-1) @ w1)
        c = D // 4
        g0 = _pad(h[:, :, 0*c:1*c], ((0, 0), (1, 0), (0, 0)))[:, :S, :]
        g1 = _pad(h[:, :, 1*c:2*c], ((0, 0), (0, 1), (0, 0)))[:, 1:, :]
        g2 = _pad(h[:, :, 2*c:3*c], ((0, 0), (2, 0), (0, 0)))[:, :S, :]
        g3 = _pad(h[:, :, 3*c:   ], ((0, 0), (0, 2), (0, 0)))[:, 2:, :]
        hs = torch.concatenate([g0, g1, g2, g3], axis=-1) @ w2
        x1 = x + hs
        h2 = _gelu(_layernorm(x1, axis=-1) @ w3) @ w4
        return x1 + h2

    x = A_q
    g = _sigmoid((x * gate_w).sum(-1, keepdims=True))
    a = _A_ref(x, A_k, A_v, A_shift_k, A_ssm_k, A_ssm_D)
    b = _B_ref(x, B_w1, B_w2, B_w3, B_w4)
    return g * a + (1 - g) * b
```

```asm
; @launch grid=(256,1,1) block=(1024,1,1) lds=163840
.amdgcn_target "amdgcn-amd-amdhsa--gfx950"
.text
.globl gated_mix__ssm_conv_h3__mixer_s_mlp__prompt_kernel
.p2align 8
.type gated_mix__ssm_conv_h3__mixer_s_mlp__prompt_kernel,@function
gated_mix__ssm_conv_h3__mixer_s_mlp__prompt_kernel:
    s_cmp_ge_u32 s2, 256
    s_cbranch_scc1 k3_done_x

    v_lshrrev_b32 v1, 6, v0
    s_nop 0
    v_readfirstlane_b32 s101, v1
    s_cmp_ge_u32 s2, 144
    s_cbranch_scc1 kf_side
    s_mov_b32 s3, s2

    s_load_dwordx2 s[4:5], s[0:1], 56
    s_load_dwordx2 s[12:13], s[0:1], 0
    s_load_dwordx2 s[8:9], s[0:1], 112
    s_load_dwordx2 s[10:11], s[0:1], 88
    s_load_dwordx2 s[6:7], s[0:1], 64
    s_load_dwordx2 s[14:15], s[0:1], 104
    s_and_b32 s40, s3, 7
    s_lshr_b32 s41, s3, 3
    s_cmp_ge_u32 s41, 9
    s_cselect_b32 s42, 1, 0
    s_lshl_b32 s36, s40, 1
    s_add_u32 s36, s36, s42
    s_mul_i32 s42, s42, 9
    s_sub_u32 s37, s41, s42

    v_lshrrev_b32 v1, 6, v0
    s_lshl_b32 s61, s36, 7
    v_readfirstlane_b32 s38, v1
    v_and_b32 v0, 63, v0
    s_mov_b32 s53, 0x8000
    s_cmp_ge_u32 s38, 4
    s_cbranch_scc1 g1_comp

    v_lshrrev_b32 v10, 3, v0
    v_and_b32 v11, 7, v0
    v_lshrrev_b32 v12, 1, v10
    v_xor_b32 v13, v11, v12
    v_mul_u32_u24 v8, 1152, v10
    v_xor_b32 v14, 4, v13
    v_lshl_add_u32 v5, v14, 4, v8
    v_lshl_add_u32 v4, v13, 4, v8
    v_add_u32 v5, 8192, v5
    s_and_b32 s44, s36, 1
    s_lshl_b32 s44, s44, 2
    s_add_u32 s44, s44, s37
    s_cmp_ge_u32 s44, 9
    s_cselect_b32 s45, 9, 0
    s_sub_u32 s62, s44, s45
    s_mul_i32 s44, s62, 1
    s_lshl_b32 s58, s44, 7
    s_mov_b32 s60, s58
    s_mul_i32 s59, s44, 73728
    s_lshl_b32 s44, s38, 5
    s_add_u32 s44, s44, s61
    s_mul_i32 s46, s44, 1152
    s_lshl_b32 s48, s38, 12
    s_add_u32 s48, s48, 73728
    s_waitcnt lgkmcnt(0)

    s_mov_b32 s28, s12
    s_and_b32 s29, s13, 0xffff
    s_mov_b32 s30, 2359296
    s_mov_b32 s31, 0x20000
    s_add_u32 m0, s48, 0
    s_add_u32 s50, s46, s58
    buffer_load_dwordx4 v4, s[28:31], s50 offen lds
    buffer_load_dwordx4 v5, s[28:31], s50 offen offset:1024 lds
    s_add_u32 s50, s50, 16384
    buffer_load_dwordx4 v4, s[28:31], s50 offen offset:2048 lds
    buffer_load_dwordx4 v5, s[28:31], s50 offen offset:3072 lds
    s_add_u32 s58, s58, 128
    s_cmp_eq_u32 s58, 1152
    s_cselect_b32 s58, 0, s58
    s_mov_b32 s16, s4
    s_and_b32 s17, s5, 0xffff
    s_mov_b32 s18, 663552
    s_mov_b32 s19, 0x20000
    v_and_b32 v12, 6, v10
    v_xor_b32 v9, v11, v12
    v_and_b32 v12, 4, v10
    v_lshlrev_b32 v12, 1, v12
    v_and_b32 v14, 3, v10
    v_add_u32 v12, v12, v14
    v_mul_u32_u24 v6, 1152, v12
    v_lshl_add_u32 v6, v9, 4, v6
    v_add_u32 v7, 17408, v6
    s_lshr_b32 s44, s38, 1
    s_mul_i32 s47, s44, 36864
    s_and_b32 s44, s38, 1
    s_mul_i32 s44, s44, 4608
    s_add_u32 s47, s47, s44
    s_lshl_b32 s63, s37, 7
    s_add_u32 s47, s47, s63
    s_lshl_b32 s49, s38, 11

    s_add_u32 m0, s49, 0
    s_add_u32 s50, s47, s59
    buffer_load_dwordx4 v6, s[16:19], s50 offen lds
    buffer_load_dwordx4 v7, s[16:19], s50 offen offset:1024 lds
    s_add_u32 s59, s59, 73728
    s_cmp_eq_u32 s59, 663552
    s_cselect_b32 s59, 0, s59
    s_mov_b32 s20, s10
    s_and_b32 s21, s11, 0xffff
    s_mov_b32 s22, 1152
    s_mov_b32 s23, 0x20000
    s_min_u32 s44, s38, 2
    s_lshl_b32 s44, s44, 10
    s_add_u32 m0, s44, 155648
    v_lshl_add_u32 v15, v0, 4, s44
    v_add_u32 v13, s60, v15
    v_subrev_u32 v12, 1152, v13
    v_cmp_le_u32 vcc, 1152, v13
    s_nop 1
    v_cndmask_b32 v13, v13, v12, vcc
    v_cmp_le_u32 vcc, 1152, v15
    s_nop 1
    v_cndmask_b32 v15, v13, v15, vcc

    buffer_load_dwordx4 v15, s[20:23], 0 offen lds
    s_mov_b32 s40, s14
    s_and_b32 s41, s15, 0xffff
    s_mov_b32 s42, 256
    s_mov_b32 s43, 0x20000
    v_mov_b32 v16, 0
    s_mov_b32 s32, s6
    s_and_b32 s33, s7, 0xffff
    s_mov_b32 s34, 663552
    s_mov_b32 s35, 0x20000
    v_lshl_add_u32 v18, v9, 4, v8
    v_add_u32 v19, 8192, v18
    s_lshr_b32 s44, s38, 1
    s_mul_i32 s52, s44, 36864
    s_and_b32 s44, s38, 1
    s_mul_i32 s44, s44, 18432
    s_add_u32 s52, s52, s44
    s_add_u32 s52, s52, s63

    s_add_u32 m0, s49, 8192
    s_add_u32 s50, s47, s59
    buffer_load_dwordx4 v6, s[16:19], s50 offen lds
    buffer_load_dwordx4 v7, s[16:19], s50 offen offset:1024 lds
    s_add_u32 s59, s59, 73728
    s_cmp_eq_u32 s59, 663552
    s_cselect_b32 s59, 0, s59
    s_add_u32 m0, s48, 16384
    s_add_u32 s50, s46, s58
    buffer_load_dwordx4 v4, s[28:31], s50 offen lds
    buffer_load_dwordx4 v5, s[28:31], s50 offen offset:1024 lds
    s_add_u32 s50, s50, 16384
    buffer_load_dwordx4 v4, s[28:31], s50 offen offset:2048 lds
    buffer_load_dwordx4 v5, s[28:31], s50 offen offset:3072 lds
    s_add_u32 s58, s58, 128
    s_cmp_eq_u32 s58, 1152
    s_cselect_b32 s58, 0, s58
    s_add_u32 m0, s48, 32768
    s_add_u32 s50, s46, s58
    buffer_load_dwordx4 v4, s[28:31], s50 offen lds
    buffer_load_dwordx4 v5, s[28:31], s50 offen offset:1024 lds
    s_add_u32 s50, s50, 16384
    buffer_load_dwordx4 v4, s[28:31], s50 offen offset:2048 lds
    buffer_load_dwordx4 v5, s[28:31], s50 offen offset:3072 lds
    s_add_u32 s58, s58, 128
    s_cmp_eq_u32 s58, 1152
    s_cselect_b32 s58, 0, s58
    s_add_u32 m0, s49, 16384
    s_add_u32 s50, s47, s59
    buffer_load_dwordx4 v6, s[16:19], s50 offen lds
    buffer_load_dwordx4 v7, s[16:19], s50 offen offset:1024 lds
    s_add_u32 s59, s59, 73728
    s_cmp_eq_u32 s59, 663552
    s_cselect_b32 s59, 0, s59
    s_add_u32 m0, s48, 49152
    s_add_u32 s50, s46, s58
    buffer_load_dwordx4 v4, s[28:31], s50 offen lds
    buffer_load_dwordx4 v5, s[28:31], s50 offen offset:1024 lds
    s_add_u32 s50, s50, 16384
    buffer_load_dwordx4 v4, s[28:31], s50 offen offset:2048 lds
    buffer_load_dwordx4 v5, s[28:31], s50 offen offset:3072 lds
    s_add_u32 s58, s58, 128
    s_cmp_eq_u32 s58, 1152
    s_cselect_b32 s58, 0, s58
    s_waitcnt vmcnt(16)
    s_barrier
    s_add_u32 m0, s49, 24576
    s_add_u32 s50, s47, s59
    buffer_load_dwordx4 v6, s[16:19], s50 offen lds
    buffer_load_dwordx4 v7, s[16:19], s50 offen offset:1024 lds
    s_add_u32 s59, s59, 73728
    s_cmp_eq_u32 s59, 663552
    s_cselect_b32 s59, 0, s59
    s_add_u32 m0, s48, 65536
    s_add_u32 s50, s46, s58
    buffer_load_dwordx4 v4, s[28:31], s50 offen lds
    buffer_load_dwordx4 v5, s[28:31], s50 offen offset:1024 lds
    s_add_u32 s50, s50, 16384
    buffer_load_dwordx4 v4, s[28:31], s50 offen offset:2048 lds
    buffer_load_dwordx4 v5, s[28:31], s50 offen offset:3072 lds
    s_add_u32 s58, s58, 128
    s_cmp_eq_u32 s58, 1152
    s_cselect_b32 s58, 0, s58
    s_waitcnt vmcnt(16)
    s_barrier
    s_add_u32 m0, s49, 32768
    s_add_u32 s50, s47, s59
    buffer_load_dwordx4 v6, s[16:19], s50 offen lds
    buffer_load_dwordx4 v7, s[16:19], s50 offen offset:1024 lds
    s_add_u32 s59, s59, 73728
    s_cmp_eq_u32 s59, 663552
    s_cselect_b32 s59, 0, s59
    s_waitcnt vmcnt(12)
    s_barrier
    s_add_u32 m0, s48, 0
    s_add_u32 s50, s46, s58
    buffer_load_dwordx4 v4, s[28:31], s50 offen lds
    buffer_load_dwordx4 v5, s[28:31], s50 offen offset:1024 lds
    s_add_u32 s50, s50, 16384
    buffer_load_dwordx4 v4, s[28:31], s50 offen offset:2048 lds
    buffer_load_dwordx4 v5, s[28:31], s50 offen offset:3072 lds
    s_add_u32 s58, s58, 128
    s_cmp_eq_u32 s58, 1152
    s_cselect_b32 s58, 0, s58
    s_add_u32 m0, s49, 40960
    s_add_u32 s50, s47, s59
    buffer_load_dwordx4 v6, s[16:19], s50 offen lds
    buffer_load_dwordx4 v7, s[16:19], s50 offen offset:1024 lds
    s_add_u32 s59, s59, 73728
    s_cmp_eq_u32 s59, 663552
    s_cselect_b32 s59, 0, s59
    s_waitcnt vmcnt(12)
    s_barrier
    s_add_u32 m0, s48, 16384
    s_add_u32 s50, s46, s58
    buffer_load_dwordx4 v4, s[28:31], s50 offen lds
    buffer_load_dwordx4 v5, s[28:31], s50 offen offset:1024 lds
    s_add_u32 s50, s50, 16384
    buffer_load_dwordx4 v4, s[28:31], s50 offen offset:2048 lds
    buffer_load_dwordx4 v5, s[28:31], s50 offen offset:3072 lds
    s_add_u32 s58, s58, 128
    s_cmp_eq_u32 s58, 1152
    s_cselect_b32 s58, 0, s58
    s_add_u32 m0, s49, 49152
    s_add_u32 s50, s47, s59
    buffer_load_dwordx4 v6, s[16:19], s50 offen lds
    buffer_load_dwordx4 v7, s[16:19], s50 offen offset:1024 lds
    s_add_u32 s59, s59, 73728
    s_cmp_eq_u32 s59, 663552
    s_cselect_b32 s59, 0, s59
    s_waitcnt vmcnt(12)
    s_barrier
    s_add_u32 m0, s48, 32768
    s_add_u32 s50, s46, s58
    buffer_load_dwordx4 v4, s[28:31], s50 offen lds
    buffer_load_dwordx4 v5, s[28:31], s50 offen offset:1024 lds
    s_add_u32 s50, s50, 16384
    buffer_load_dwordx4 v4, s[28:31], s50 offen offset:2048 lds
    buffer_load_dwordx4 v5, s[28:31], s50 offen offset:3072 lds
    s_add_u32 s58, s58, 128
    s_cmp_eq_u32 s58, 1152
    s_cselect_b32 s58, 0, s58
    buffer_load_dword v17, v16, s[40:43], 0 offen sc1
    s_add_u32 m0, s49, 57344
    s_add_u32 s50, s47, s59
    buffer_load_dwordx4 v6, s[16:19], s50 offen lds
    buffer_load_dwordx4 v7, s[16:19], s50 offen offset:1024 lds
    s_add_u32 s59, s59, 73728
    s_cmp_eq_u32 s59, 663552
    s_cselect_b32 s59, 0, s59
    s_waitcnt vmcnt(13)
    s_barrier
    s_add_u32 m0, s48, 49152
    s_add_u32 s50, s46, s58
    buffer_load_dwordx4 v4, s[28:31], s50 offen lds
    buffer_load_dwordx4 v5, s[28:31], s50 offen offset:1024 lds
    s_add_u32 s50, s50, 16384
    buffer_load_dwordx4 v4, s[28:31], s50 offen offset:2048 lds
    buffer_load_dwordx4 v5, s[28:31], s50 offen offset:3072 lds
    s_add_u32 s58, s58, 128
    s_cmp_eq_u32 s58, 1152
    s_cselect_b32 s58, 0, s58
    s_add_u32 m0, s49, 65536
    s_add_u32 s50, s47, s59
    buffer_load_dwordx4 v6, s[16:19], s50 offen lds
    buffer_load_dwordx4 v7, s[16:19], s50 offen offset:1024 lds
    s_add_u32 s59, s59, 73728
    s_cmp_eq_u32 s59, 663552
    s_cselect_b32 s59, 0, s59
    s_add_u32 m0, s49, 0
    s_add_u32 s50, s52, 0
    buffer_load_dwordx4 v18, s[32:35], s50 offen lds
    buffer_load_dwordx4 v19, s[32:35], s50 offen offset:1024 lds
    s_add_u32 m0, s49, 8192
    s_add_u32 s50, s52, 73728
    buffer_load_dwordx4 v18, s[32:35], s50 offen lds
    buffer_load_dwordx4 v19, s[32:35], s50 offen offset:1024 lds
    s_add_u32 m0, s49, 16384
    s_add_u32 s50, s52, 147456
    buffer_load_dwordx4 v18, s[32:35], s50 offen lds
    buffer_load_dwordx4 v19, s[32:35], s50 offen offset:1024 lds
    s_add_u32 m0, s49, 24576
    s_add_u32 s50, s52, 221184
    buffer_load_dwordx4 v18, s[32:35], s50 offen lds
    buffer_load_dwordx4 v19, s[32:35], s50 offen offset:1024 lds
    s_waitcnt vmcnt(21)
    s_barrier
    s_add_u32 m0, s49, 32768
    s_add_u32 s50, s52, 294912
    buffer_load_dwordx4 v18, s[32:35], s50 offen lds
    buffer_load_dwordx4 v19, s[32:35], s50 offen offset:1024 lds
    s_waitcnt vmcnt(16)
    s_barrier
    s_add_u32 m0, s49, 40960
    s_add_u32 s50, s52, 368640
    buffer_load_dwordx4 v18, s[32:35], s50 offen lds
    buffer_load_dwordx4 v19, s[32:35], s50 offen offset:1024 lds
    s_waitcnt vmcnt(12)
    s_barrier
    v_cmp_ne_u32 vcc, 1, v17
    s_cbranch_vccz g_val_ok
g_val:
    buffer_load_dword v17, v16, s[40:43], 0 offen sc1
g_val_chk:
    s_waitcnt vmcnt(0)
    v_cmp_ne_u32 vcc, 1, v17
    s_cbranch_vccz g_val_ok
    s_sub_u32 s53, s53, 1
    s_cbranch_scc1 g_val_ok
    s_sleep 4
    s_branch g_val
g_val_ok:
    s_add_u32 s20, s8, 35651584
    s_addc_u32 s21, s9, 0
    s_and_b32 s21, s21, 0xffff
    s_mov_b32 s22, 2621440
    s_mov_b32 s23, 0x20000
    v_lshlrev_b32 v4, 4, v0
    v_xor_b32 v12, v11, v10
    v_lshl_add_u32 v5, v12, 4, v8
    s_add_u32 s51, s46, s63
    s_lshl_b32 s44, s36, 3
    s_lshl_b32 s45, s38, 1
    s_add_u32 s45, s44, s45
    s_mul_i32 s46, s45, 20480
    s_add_u32 s47, s46, 19456
    s_sub_u32 s45, s44, 1
    s_mul_i32 s58, s45, 20480
    s_cmp_eq_u32 s36, 0
    s_cselect_b32 s58, 0x70000000, s58
    s_add_u32 s45, s44, 8
    s_mul_i32 s59, s45, 20480
    s_lshl_b32 s60, s38, 11
    s_add_u32 s60, s60, 73728
    s_barrier

    s_barrier
    s_add_u32 m0, s49, 49152
    s_add_u32 s50, s52, 442368
    buffer_load_dwordx4 v18, s[32:35], s50 offen lds
    buffer_load_dwordx4 v19, s[32:35], s50 offen offset:1024 lds
    s_add_u32 m0, s49, 57344
    s_add_u32 s50, s52, 516096
    buffer_load_dwordx4 v18, s[32:35], s50 offen lds
    buffer_load_dwordx4 v19, s[32:35], s50 offen offset:1024 lds
    s_add_u32 m0, s49, 65536
    s_add_u32 s50, s52, 589824
    buffer_load_dwordx4 v18, s[32:35], s50 offen lds
    buffer_load_dwordx4 v19, s[32:35], s50 offen offset:1024 lds
    s_barrier
    s_add_u32 m0, s60, 1024
    s_add_u32 s50, s46, 0
    buffer_load_dwordx4 v4, s[20:23], s50 offen sc1 lds
    s_add_u32 s50, s47, 0
    buffer_load_dwordx4 v4, s[20:23], s50 offen offset:1024 sc1 lds
    s_add_u32 m0, s60, 10240
    s_add_u32 s50, s46, 1024
    buffer_load_dwordx4 v4, s[20:23], s50 offen sc1 lds
    s_add_u32 s50, s47, 1024
    buffer_load_dwordx4 v4, s[20:23], s50 offen offset:1024 sc1 lds
    s_add_u32 s44, s58, 0
    s_add_u32 s45, s58, 1024
    s_mov_b32 s50, 73728
    s_bitcmp1_b32 s38, 0
    s_cselect_b32 m0, 82944, s50
    s_cselect_b32 s50, s45, s44
    buffer_load_dwordx4 v4, s[20:23], s50 offen sc1 lds
    s_add_u32 m0, s60, 19456
    s_add_u32 s50, s46, 2048
    buffer_load_dwordx4 v4, s[20:23], s50 offen sc1 lds
    s_add_u32 s50, s47, 2048
    buffer_load_dwordx4 v4, s[20:23], s50 offen offset:1024 sc1 lds
    s_add_u32 m0, s60, 28672
    s_add_u32 s50, s46, 3072
    buffer_load_dwordx4 v4, s[20:23], s50 offen sc1 lds
    s_add_u32 s50, s47, 3072
    buffer_load_dwordx4 v4, s[20:23], s50 offen offset:1024 sc1 lds
    s_add_u32 s44, s58, 2048
    s_add_u32 s45, s58, 3072
    s_mov_b32 s50, 92160
    s_bitcmp1_b32 s38, 0
    s_cselect_b32 m0, 101376, s50
    s_cselect_b32 s50, s45, s44
    buffer_load_dwordx4 v4, s[20:23], s50 offen sc1 lds
    s_add_u32 m0, s60, 37888
    s_add_u32 s50, s46, 4096
    buffer_load_dwordx4 v4, s[20:23], s50 offen sc1 lds
    s_add_u32 s50, s47, 4096
    buffer_load_dwordx4 v4, s[20:23], s50 offen offset:1024 sc1 lds
    s_add_u32 m0, s60, 46080
    s_add_u32 s50, s46, 5120
    buffer_load_dwordx4 v4, s[20:23], s50 offen sc1 lds
    s_add_u32 s50, s47, 5120
    buffer_load_dwordx4 v4, s[20:23], s50 offen offset:1024 sc1 lds
    s_add_u32 s44, s58, 4096
    s_add_u32 s45, s59, 5120
    s_mov_b32 s50, 110592
    s_bitcmp1_b32 s38, 0
    s_cselect_b32 m0, 128000, s50
    s_cselect_b32 s50, s45, s44
    buffer_load_dwordx4 v4, s[20:23], s50 offen sc1 lds
    s_waitcnt vmcnt(10)
    s_barrier
    s_add_u32 m0, s60, 55296
    s_add_u32 s50, s46, 6144
    buffer_load_dwordx4 v4, s[20:23], s50 offen sc1 lds
    s_add_u32 s50, s47, 6144
    buffer_load_dwordx4 v4, s[20:23], s50 offen offset:1024 sc1 lds
    s_add_u32 m0, s60, 64512
    s_add_u32 s50, s46, 7168
    buffer_load_dwordx4 v4, s[20:23], s50 offen sc1 lds
    s_add_u32 s50, s47, 7168
    buffer_load_dwordx4 v4, s[20:23], s50 offen offset:1024 sc1 lds
    s_add_u32 s44, s59, 6144
    s_add_u32 s45, s59, 7168
    s_mov_b32 s50, 137216
    s_bitcmp1_b32 s38, 0
    s_cselect_b32 m0, 146432, s50
    s_cselect_b32 s50, s45, s44
    buffer_load_dwordx4 v4, s[20:23], s50 offen sc1 lds
    s_waitcnt vmcnt(10)
    s_barrier
    s_add_u32 m0, s60, 0
    s_add_u32 s50, s46, 8192
    buffer_load_dwordx4 v4, s[20:23], s50 offen sc1 lds
    s_add_u32 s50, s47, 8192
    buffer_load_dwordx4 v4, s[20:23], s50 offen offset:1024 sc1 lds
    s_add_u32 m0, s60, 10240
    s_add_u32 s50, s46, 9216
    buffer_load_dwordx4 v4, s[20:23], s50 offen sc1 lds
    s_add_u32 s50, s47, 9216
    buffer_load_dwordx4 v4, s[20:23], s50 offen offset:1024 sc1 lds
    s_add_u32 s44, s59, 8192
    s_add_u32 s45, s58, 9216
    s_mov_b32 s50, 81920
    s_bitcmp1_b32 s38, 0
    s_cselect_b32 m0, 82944, s50
    s_cselect_b32 s50, s45, s44
    buffer_load_dwordx4 v4, s[20:23], s50 offen sc1 lds
    s_waitcnt vmcnt(10)
    s_barrier
    s_add_u32 m0, s60, 19456
    s_add_u32 s50, s46, 10240
    buffer_load_dwordx4 v4, s[20:23], s50 offen sc1 lds
    s_add_u32 s50, s47, 10240
    buffer_load_dwordx4 v4, s[20:23], s50 offen offset:1024 sc1 lds
    s_add_u32 m0, s60, 28672
    s_add_u32 s50, s46, 11264
    buffer_load_dwordx4 v4, s[20:23], s50 offen sc1 lds
    s_add_u32 s50, s47, 11264
    buffer_load_dwordx4 v4, s[20:23], s50 offen offset:1024 sc1 lds
    s_add_u32 s44, s58, 10240
    s_add_u32 s45, s58, 11264
    s_mov_b32 s50, 92160
    s_bitcmp1_b32 s38, 0
    s_cselect_b32 m0, 101376, s50
    s_cselect_b32 s50, s45, s44
    buffer_load_dwordx4 v4, s[20:23], s50 offen sc1 lds
    s_waitcnt vmcnt(10)
    s_barrier
    s_add_u32 m0, s60, 37888
    s_add_u32 s50, s46, 12288
    buffer_load_dwordx4 v4, s[20:23], s50 offen sc1 lds
    s_add_u32 s50, s47, 12288
    buffer_load_dwordx4 v4, s[20:23], s50 offen offset:1024 sc1 lds
    s_add_u32 m0, s60, 47104
    s_add_u32 s50, s46, 13312
    buffer_load_dwordx4 v4, s[20:23], s50 offen sc1 lds
    s_add_u32 s50, s47, 13312
    buffer_load_dwordx4 v4, s[20:23], s50 offen offset:1024 sc1 lds
    s_add_u32 s44, s58, 12288
    s_add_u32 s45, s58, 13312
    s_mov_b32 s50, 110592
    s_bitcmp1_b32 s38, 0
    s_cselect_b32 m0, 119808, s50
    s_cselect_b32 s50, s45, s44
    buffer_load_dwordx4 v4, s[20:23], s50 offen sc1 lds
    s_waitcnt vmcnt(10)
    s_barrier
    s_add_u32 m0, s60, 55296
    s_add_u32 s50, s46, 14336
    buffer_load_dwordx4 v4, s[20:23], s50 offen sc1 lds
    s_add_u32 s50, s47, 14336
    buffer_load_dwordx4 v4, s[20:23], s50 offen offset:1024 sc1 lds
    s_add_u32 m0, s60, 64512
    s_add_u32 s50, s46, 15360
    buffer_load_dwordx4 v4, s[20:23], s50 offen sc1 lds
    s_add_u32 s50, s47, 15360
    buffer_load_dwordx4 v4, s[20:23], s50 offen offset:1024 sc1 lds
    s_add_u32 s44, s59, 14336
    s_add_u32 s45, s59, 15360
    s_mov_b32 s50, 137216
    s_bitcmp1_b32 s38, 0
    s_cselect_b32 m0, 146432, s50
    s_cselect_b32 s50, s45, s44
    buffer_load_dwordx4 v4, s[20:23], s50 offen sc1 lds
    s_waitcnt vmcnt(10)
    s_barrier
    s_add_u32 m0, s60, 0
    s_add_u32 s50, s46, 16384
    buffer_load_dwordx4 v4, s[20:23], s50 offen sc1 lds
    s_add_u32 s50, s47, 16384
    buffer_load_dwordx4 v4, s[20:23], s50 offen offset:1024 sc1 lds
    s_add_u32 m0, s60, 9216
    s_add_u32 s50, s46, 17408
    buffer_load_dwordx4 v4, s[20:23], s50 offen sc1 lds
    s_add_u32 s50, s47, 17408
    buffer_load_dwordx4 v4, s[20:23], s50 offen offset:1024 sc1 lds
    s_add_u32 s44, s59, 16384
    s_add_u32 s45, s59, 17408
    s_mov_b32 s50, 81920
    s_bitcmp1_b32 s38, 0
    s_cselect_b32 m0, 91136, s50
    s_cselect_b32 s50, s45, s44
    buffer_load_dwordx4 v4, s[20:23], s50 offen sc1 lds
    s_waitcnt vmcnt(10)
    s_barrier
    s_add_u32 m0, s60, 18432
    s_add_u32 s50, s46, 18432
    buffer_load_dwordx4 v4, s[20:23], s50 offen sc1 lds
    s_add_u32 s50, s47, 18432
    buffer_load_dwordx4 v4, s[20:23], s50 offen offset:1024 sc1 lds
    s_add_u32 m0, s60, 27648
    s_add_u32 s50, s46, 19456
    buffer_load_dwordx4 v4, s[20:23], s50 offen sc1 lds
    s_add_u32 s50, s47, 19456
    buffer_load_dwordx4 v4, s[20:23], s50 offen offset:1024 sc1 lds
    s_add_u32 s44, s59, 18432
    s_add_u32 s45, s59, 19456
    s_mov_b32 s50, 100352
    s_bitcmp1_b32 s38, 0
    s_cselect_b32 m0, 109568, s50
    s_cselect_b32 s50, s45, s44
    buffer_load_dwordx4 v4, s[20:23], s50 offen sc1 lds
    s_sub_u32 m0, s48, 73728
    s_add_u32 s50, s51, 0
    buffer_load_dwordx4 v5, s[28:31], s50 offen lds
    s_sub_u32 m0, s48, 72704
    s_add_u32 s50, s51, 9216
    buffer_load_dwordx4 v5, s[28:31], s50 offen lds
    s_sub_u32 m0, s48, 71680
    s_add_u32 s50, s51, 18432
    buffer_load_dwordx4 v5, s[28:31], s50 offen lds
    s_sub_u32 m0, s48, 70656
    s_add_u32 s50, s51, 27648
    buffer_load_dwordx4 v5, s[28:31], s50 offen lds
    s_waitcnt vmcnt(14)
    s_barrier
    s_waitcnt vmcnt(9)
    s_barrier
    s_waitcnt vmcnt(0)
    s_barrier
    s_barrier
    s_branch k3_entry
g1_comp:
    s_cmp_lt_u32 s38, 12
    s_cbranch_scc1 g1_cc
    s_barrier
    s_barrier
    s_barrier
    s_barrier
    s_barrier
    s_barrier
    s_barrier
    s_barrier
    s_barrier
    s_barrier
    s_barrier
    s_barrier
    s_barrier
    s_barrier
    s_barrier
    s_barrier
    s_barrier
    s_barrier
    s_barrier
    s_barrier
    s_barrier
    s_barrier
    s_barrier
    s_branch k3_entry
g1_cc:
    s_sub_u32 s38, s38, 4
    v_and_b32 v2, 15, v0
    v_lshrrev_b32 v3, 4, v0
    s_lshr_b32 s39, s38, 1
    s_and_b32 s55, s38, 1
    s_lshl_b32 s44, s38, 10
    v_lshl_add_u32 v8, v0, 4, s44
    v_mov_b32 v120, 0x3f803f80
    v_mov_b32 v121, 0x3f803f80
    v_mov_b32 v122, 0x3f803f80
    v_mov_b32 v123, 0x3f803f80
    v_cmp_gt_u32 vcc, 1152, v8
    v_add_u32 v8, 158720, v8
    v_mov_b32 v10, 160128
    v_mov_b32 v11, 0
    s_and_saveexec_b64 s[56:57], vcc
    ds_write_b128 v8, v[120:123]
    ds_write_b32 v10, v11
    s_mov_b64 exec, s[56:57]
    v_lshrrev_b32 v10, 2, v0
    v_lshlrev_b32 v10, 7, v10
    v_and_b32 v11, 3, v0
    v_lshl_add_u32 v22, v11, 3, v10
    v_bfe_u32 v23, v0, 3, 2
    s_lshl_b32 s44, s55, 1
    s_and_b32 s45, s39, 1
    s_add_u32 s54, s44, s45
    v_xor_b32 v11, s54, v23
    v_lshl_add_u32 v14, v11, 5, v22
    v_xor_b32 v11, 1, v11
    v_lshl_add_u32 v15, v11, 5, v22
    v_lshrrev_b32 v11, 1, v2
    v_xor_b32 v11, v3, v11
    v_lshlrev_b32 v10, 7, v2
    v_lshl_add_u32 v16, v11, 4, v10
    v_xor_b32 v17, 64, v16
    s_lshl_b32 s44, s39, 12
    s_lshl_b32 s45, s55, 11
    s_add_u32 s44, s44, 73728
    s_add_u32 s51, s44, s45
    s_xor_b32 s45, s45, 2048
    s_add_u32 s52, s44, s45
    v_add_u32 v18, s52, v16
    v_add_u32 v19, s52, v17
    v_add_u32 v16, s51, v16
    v_add_u32 v17, s51, v17
    v_and_b32 v11, 3, v0
    v_mov_b32 v20, 156928
    v_mov_b32 v10, 158720
    v_cmp_eq_u32 vcc, 0, v11
    s_nop 1
    v_cndmask_b32 v20, v20, v10, vcc
    v_mov_b32 v10, 155648
    v_cmp_eq_u32 vcc, 1, v11
    s_nop 1
    v_cndmask_b32 v20, v20, v10, vcc
    v_lshl_add_u32 v20, v3, 4, v20
    s_waitcnt lgkmcnt(0)

    s_add_u32 s24, s8, 35651584
    s_addc_u32 s25, s9, 0
    s_and_b32 s25, s25, 0xffff
    s_mov_b32 s26, 2621440
    s_mov_b32 s27, 0x20000
    s_add_u32 s32, s8, 12058624
    s_addc_u32 s33, s9, 0
    s_and_b32 s33, s33, 0xffff
    s_mov_b32 s34, 8192
    s_mov_b32 s35, 0x20000
    s_add_u32 s40, s8, 12189696
    s_addc_u32 s41, s9, 0
    s_and_b32 s41, s41, 0xffff
    s_mov_b32 s42, 13312
    s_mov_b32 s43, 0x20000
    s_lshl_b32 s44, s36, 3
    s_add_u32 s45, s44, s38
    s_mul_i32 s48, s45, 20480
    s_xor_b32 s45, s45, 1
    s_mul_i32 s49, s45, 20480
    s_lshl_b32 s52, s37, 1
    s_add_u32 s52, s52, s55
    v_lshlrev_b32 v4, 4, v0
    s_lshl_b32 s44, s52, 10
    v_add_u32 v5, s44, v4

    s_lshl_b32 s44, s38, 8
    s_add_u32 s44, s44, 160256
    v_lshl_add_u32 v12, v2, 4, s44
    s_lshl_b32 s45, s54, 6
    s_add_u32 s45, s45, 159872
    v_lshl_add_u32 v13, v3, 4, s45
    v_lshlrev_b32 v10, 2, v3
    v_sub_u32 v10, v2, v10
    v_cmp_eq_u32 s[58:59], 0, v10
    v_cmp_eq_u32 s[46:47], 1, v10
    v_cmp_eq_u32 s[62:63], 2, v10
    v_cmp_eq_u32 s[50:51], 3, v10
    v_cmp_eq_u32 s[56:57], 0, v2
    s_lshl_b32 s60, s36, 8
    s_lshl_b32 s44, s37, 2
    s_add_u32 s60, s60, s44

    s_barrier
    ds_read_b128 v[88:91], v20 offset:0
    ds_read_b128 v[40:43], v16 offset:0
    ds_read_b128 v[44:47], v18 offset:0
    ds_read_b64_tr_b16 v[24:25], v14 offset:0
    ds_read_b64_tr_b16 v[26:27], v14 offset:2048
    ds_read_b64_tr_b16 v[28:29], v15 offset:0
    ds_read_b64_tr_b16 v[30:31], v15 offset:2048
    ds_read_b128 v[48:51], v17 offset:0
    ds_read_b128 v[52:55], v19 offset:0
    ds_read_b64_tr_b16 v[32:33], v14 offset:4096
    ds_read_b64_tr_b16 v[34:35], v14 offset:6144
    ds_read_b64_tr_b16 v[36:37], v15 offset:4096
    ds_read_b64_tr_b16 v[38:39], v15 offset:6144
    s_barrier
    s_waitcnt lgkmcnt(6)
    ds_read_b128 v[92:95], v20 offset:64
    v_mfma_f32_16x16x32_bf16 v[96:99], v[24:27], v[40:43], 0
    ds_read_b128 v[72:75], v16 offset:16384
    v_mfma_f32_16x16x32_bf16 v[100:103], v[24:27], v[44:47], 0
    ds_read_b128 v[76:79], v18 offset:16384
    v_mfma_f32_16x16x32_bf16 v[104:107], v[28:31], v[40:43], 0
    ds_read_b64_tr_b16 v[56:57], v14 offset:8192
    v_mfma_f32_16x16x32_bf16 v[108:111], v[28:31], v[44:47], 0
    ds_read_b64_tr_b16 v[58:59], v14 offset:10240
    v_mfma_f32_16x16x32_bf16 v[124:127], v[40:43], v[40:43], 0
    ds_read_b64_tr_b16 v[60:61], v15 offset:8192
    v_mfma_f32_16x16x32_bf16 v[116:119], v[24:27], v[120:123], 0
    ds_read_b64_tr_b16 v[62:63], v15 offset:10240
    v_mfma_f32_16x16x32_bf16 v[112:115], v[88:91], v[40:43], 0
    s_waitcnt lgkmcnt(7)
    ds_read_b128 v[88:91], v20 offset:128
    v_mfma_f32_16x16x32_bf16 v[96:99], v[32:35], v[48:51], v[96:99]
    ds_read_b128 v[80:83], v17 offset:16384
    v_mfma_f32_16x16x32_bf16 v[100:103], v[32:35], v[52:55], v[100:103]
    ds_read_b128 v[84:87], v19 offset:16384
    v_mfma_f32_16x16x32_bf16 v[104:107], v[36:39], v[48:51], v[104:107]
    ds_read_b64_tr_b16 v[64:65], v14 offset:12288
    v_mfma_f32_16x16x32_bf16 v[108:111], v[36:39], v[52:55], v[108:111]
    ds_read_b64_tr_b16 v[66:67], v14 offset:14336
    v_mfma_f32_16x16x32_bf16 v[124:127], v[48:51], v[48:51], v[124:127]
    ds_read_b64_tr_b16 v[68:69], v15 offset:12288
    v_mfma_f32_16x16x32_bf16 v[116:119], v[32:35], v[120:123], v[116:119]
    ds_read_b64_tr_b16 v[70:71], v15 offset:14336
    s_waitcnt lgkmcnt(13)
    v_mfma_f32_16x16x32_bf16 v[112:115], v[92:95], v[48:51], v[112:115]
    s_barrier
    s_waitcnt lgkmcnt(7)
    ds_read_b128 v[92:95], v20 offset:192
    v_mfma_f32_16x16x32_bf16 v[96:99], v[56:59], v[72:75], v[96:99]
    ds_read_b128 v[40:43], v16 offset:32768
    v_mfma_f32_16x16x32_bf16 v[100:103], v[56:59], v[76:79], v[100:103]
    ds_read_b128 v[44:47], v18 offset:32768
    v_mfma_f32_16x16x32_bf16 v[104:107], v[60:63], v[72:75], v[104:107]
    ds_read_b64_tr_b16 v[24:25], v14 offset:16384
    v_mfma_f32_16x16x32_bf16 v[108:111], v[60:63], v[76:79], v[108:111]
    ds_read_b64_tr_b16 v[26:27], v14 offset:18432
    v_mfma_f32_16x16x32_bf16 v[124:127], v[72:75], v[72:75], v[124:127]
    ds_read_b64_tr_b16 v[28:29], v15 offset:16384
    v_mfma_f32_16x16x32_bf16 v[116:119], v[56:59], v[120:123], v[116:119]
    ds_read_b64_tr_b16 v[30:31], v15 offset:18432
    s_waitcnt lgkmcnt(13)
    v_mfma_f32_16x16x32_bf16 v[112:115], v[88:91], v[72:75], v[112:115]
    s_waitcnt lgkmcnt(7)
    ds_read_b128 v[88:91], v20 offset:256
    v_mfma_f32_16x16x32_bf16 v[96:99], v[64:67], v[80:83], v[96:99]
    ds_read_b128 v[48:51], v17 offset:32768
    v_mfma_f32_16x16x32_bf16 v[100:103], v[64:67], v[84:87], v[100:103]
    ds_read_b128 v[52:55], v19 offset:32768
    v_mfma_f32_16x16x32_bf16 v[104:107], v[68:71], v[80:83], v[104:107]
    ds_read_b64_tr_b16 v[32:33], v14 offset:20480
    v_mfma_f32_16x16x32_bf16 v[108:111], v[68:71], v[84:87], v[108:111]
    ds_read_b64_tr_b16 v[34:35], v14 offset:22528
    v_mfma_f32_16x16x32_bf16 v[124:127], v[80:83], v[80:83], v[124:127]
    ds_read_b64_tr_b16 v[36:37], v15 offset:20480
    v_mfma_f32_16x16x32_bf16 v[116:119], v[64:67], v[120:123], v[116:119]
    ds_read_b64_tr_b16 v[38:39], v15 offset:22528
    s_waitcnt lgkmcnt(13)
    v_mfma_f32_16x16x32_bf16 v[112:115], v[92:95], v[80:83], v[112:115]
    s_barrier
    s_waitcnt lgkmcnt(7)
    ds_read_b128 v[92:95], v20 offset:320
    v_mfma_f32_16x16x32_bf16 v[96:99], v[24:27], v[40:43], v[96:99]
    ds_read_b128 v[72:75], v16 offset:49152
    v_mfma_f32_16x16x32_bf16 v[100:103], v[24:27], v[44:47], v[100:103]
    ds_read_b128 v[76:79], v18 offset:49152
    v_mfma_f32_16x16x32_bf16 v[104:107], v[28:31], v[40:43], v[104:107]
    ds_read_b64_tr_b16 v[56:57], v14 offset:24576
    v_mfma_f32_16x16x32_bf16 v[108:111], v[28:31], v[44:47], v[108:111]
    ds_read_b64_tr_b16 v[58:59], v14 offset:26624
    v_mfma_f32_16x16x32_bf16 v[124:127], v[40:43], v[40:43], v[124:127]
    ds_read_b64_tr_b16 v[60:61], v15 offset:24576
    v_mfma_f32_16x16x32_bf16 v[116:119], v[24:27], v[120:123], v[116:119]
    ds_read_b64_tr_b16 v[62:63], v15 offset:26624
    s_waitcnt lgkmcnt(13)
    v_mfma_f32_16x16x32_bf16 v[112:115], v[88:91], v[40:43], v[112:115]
    s_waitcnt lgkmcnt(7)
    ds_read_b128 v[88:91], v20 offset:384
    v_mfma_f32_16x16x32_bf16 v[96:99], v[32:35], v[48:51], v[96:99]
    ds_read_b128 v[80:83], v17 offset:49152
    v_mfma_f32_16x16x32_bf16 v[100:103], v[32:35], v[52:55], v[100:103]
    ds_read_b128 v[84:87], v19 offset:49152
    v_mfma_f32_16x16x32_bf16 v[104:107], v[36:39], v[48:51], v[104:107]
    ds_read_b64_tr_b16 v[64:65], v14 offset:28672
    v_mfma_f32_16x16x32_bf16 v[108:111], v[36:39], v[52:55], v[108:111]
    ds_read_b64_tr_b16 v[66:67], v14 offset:30720
    v_mfma_f32_16x16x32_bf16 v[124:127], v[48:51], v[48:51], v[124:127]
    ds_read_b64_tr_b16 v[68:69], v15 offset:28672
    v_mfma_f32_16x16x32_bf16 v[116:119], v[32:35], v[120:123], v[116:119]
    ds_read_b64_tr_b16 v[70:71], v15 offset:30720
    s_waitcnt lgkmcnt(13)
    v_mfma_f32_16x16x32_bf16 v[112:115], v[92:95], v[48:51], v[112:115]
    s_barrier
    s_waitcnt lgkmcnt(7)
    ds_read_b128 v[92:95], v20 offset:448
    v_mfma_f32_16x16x32_bf16 v[96:99], v[56:59], v[72:75], v[96:99]
    v_add_u32 v14, 0x8000, v14
    v_add_u32 v15, 0x8000, v15
    v_add_u32 v16, 0x10000, v16
    v_add_u32 v17, 0x10000, v17
    v_add_u32 v18, 0x10000, v18
    v_add_u32 v19, 0x10000, v19
    ds_read_b128 v[40:43], v16 offset:0
    v_mfma_f32_16x16x32_bf16 v[100:103], v[56:59], v[76:79], v[100:103]
    ds_read_b128 v[44:47], v18 offset:0
    v_mfma_f32_16x16x32_bf16 v[104:107], v[60:63], v[72:75], v[104:107]
    ds_read_b64_tr_b16 v[24:25], v14 offset:0
    v_mfma_f32_16x16x32_bf16 v[108:111], v[60:63], v[76:79], v[108:111]
    ds_read_b64_tr_b16 v[26:27], v14 offset:2048
    v_mfma_f32_16x16x32_bf16 v[124:127], v[72:75], v[72:75], v[124:127]
    ds_read_b64_tr_b16 v[28:29], v15 offset:0
    v_mfma_f32_16x16x32_bf16 v[116:119], v[56:59], v[120:123], v[116:119]
    ds_read_b64_tr_b16 v[30:31], v15 offset:2048
    s_waitcnt lgkmcnt(13)
    v_mfma_f32_16x16x32_bf16 v[112:115], v[88:91], v[72:75], v[112:115]
    s_waitcnt lgkmcnt(7)
    ds_read_b128 v[88:91], v20 offset:512
    v_mfma_f32_16x16x32_bf16 v[96:99], v[64:67], v[80:83], v[96:99]
    ds_read_b128 v[48:51], v17 offset:0
    v_mfma_f32_16x16x32_bf16 v[100:103], v[64:67], v[84:87], v[100:103]
    ds_read_b128 v[52:55], v19 offset:0
    v_mfma_f32_16x16x32_bf16 v[104:107], v[68:71], v[80:83], v[104:107]
    ds_read_b64_tr_b16 v[32:33], v14 offset:4096
    v_mfma_f32_16x16x32_bf16 v[108:111], v[68:71], v[84:87], v[108:111]
    ds_read_b64_tr_b16 v[34:35], v14 offset:6144
    v_mfma_f32_16x16x32_bf16 v[124:127], v[80:83], v[80:83], v[124:127]
    ds_read_b64_tr_b16 v[36:37], v15 offset:4096
    v_mfma_f32_16x16x32_bf16 v[116:119], v[64:67], v[120:123], v[116:119]
    ds_read_b64_tr_b16 v[38:39], v15 offset:6144
    s_waitcnt lgkmcnt(13)
    v_mfma_f32_16x16x32_bf16 v[112:115], v[92:95], v[80:83], v[112:115]
    s_barrier
    s_waitcnt lgkmcnt(7)
    ds_read_b128 v[92:95], v20 offset:576
    v_mfma_f32_16x16x32_bf16 v[96:99], v[24:27], v[40:43], v[96:99]
    v_subrev_u32 v16, 0x10000, v16
    v_subrev_u32 v17, 0x10000, v17
    v_subrev_u32 v18, 0x10000, v18
    v_subrev_u32 v19, 0x10000, v19
    ds_read_b128 v[72:75], v16 offset:0
    v_mfma_f32_16x16x32_bf16 v[100:103], v[24:27], v[44:47], v[100:103]
    ds_read_b128 v[76:79], v18 offset:0
    v_mfma_f32_16x16x32_bf16 v[104:107], v[28:31], v[40:43], v[104:107]
    ds_read_b64_tr_b16 v[56:57], v14 offset:8192
    v_mfma_f32_16x16x32_bf16 v[108:111], v[28:31], v[44:47], v[108:111]
    ds_read_b64_tr_b16 v[58:59], v14 offset:10240
    v_mfma_f32_16x16x32_bf16 v[124:127], v[40:43], v[40:43], v[124:127]
    ds_read_b64_tr_b16 v[60:61], v15 offset:8192
    v_mfma_f32_16x16x32_bf16 v[116:119], v[24:27], v[120:123], v[116:119]
    ds_read_b64_tr_b16 v[62:63], v15 offset:10240
    s_waitcnt lgkmcnt(13)
    v_mfma_f32_16x16x32_bf16 v[112:115], v[88:91], v[40:43], v[112:115]
    s_waitcnt lgkmcnt(7)
    ds_read_b128 v[88:91], v20 offset:640
    v_mfma_f32_16x16x32_bf16 v[96:99], v[32:35], v[48:51], v[96:99]
    ds_read_b128 v[80:83], v17 offset:0
    v_mfma_f32_16x16x32_bf16 v[100:103], v[32:35], v[52:55], v[100:103]
    ds_read_b128 v[84:87], v19 offset:0
    v_mfma_f32_16x16x32_bf16 v[104:107], v[36:39], v[48:51], v[104:107]
    ds_read_b64_tr_b16 v[64:65], v14 offset:12288
    v_mfma_f32_16x16x32_bf16 v[108:111], v[36:39], v[52:55], v[108:111]
    ds_read_b64_tr_b16 v[66:67], v14 offset:14336
    v_mfma_f32_16x16x32_bf16 v[124:127], v[48:51], v[48:51], v[124:127]
    ds_read_b64_tr_b16 v[68:69], v15 offset:12288
    v_mfma_f32_16x16x32_bf16 v[116:119], v[32:35], v[120:123], v[116:119]
    ds_read_b64_tr_b16 v[70:71], v15 offset:14336
    s_waitcnt lgkmcnt(13)
    v_mfma_f32_16x16x32_bf16 v[112:115], v[92:95], v[48:51], v[112:115]
    s_barrier
    s_waitcnt lgkmcnt(7)
    ds_read_b128 v[92:95], v20 offset:704
    v_mfma_f32_16x16x32_bf16 v[96:99], v[56:59], v[72:75], v[96:99]
    ds_read_b128 v[40:43], v16 offset:16384
    v_mfma_f32_16x16x32_bf16 v[100:103], v[56:59], v[76:79], v[100:103]
    ds_read_b128 v[44:47], v18 offset:16384
    v_mfma_f32_16x16x32_bf16 v[104:107], v[60:63], v[72:75], v[104:107]
    ds_read_b64_tr_b16 v[24:25], v14 offset:16384
    v_mfma_f32_16x16x32_bf16 v[108:111], v[60:63], v[76:79], v[108:111]
    ds_read_b64_tr_b16 v[26:27], v14 offset:18432
    v_mfma_f32_16x16x32_bf16 v[124:127], v[72:75], v[72:75], v[124:127]
    ds_read_b64_tr_b16 v[28:29], v15 offset:16384
    v_mfma_f32_16x16x32_bf16 v[116:119], v[56:59], v[120:123], v[116:119]
    ds_read_b64_tr_b16 v[30:31], v15 offset:18432
    s_waitcnt lgkmcnt(13)
    v_mfma_f32_16x16x32_bf16 v[112:115], v[88:91], v[72:75], v[112:115]
    s_waitcnt lgkmcnt(7)
    ds_read_b128 v[88:91], v20 offset:768
    v_mfma_f32_16x16x32_bf16 v[96:99], v[64:67], v[80:83], v[96:99]
    ds_read_b128 v[48:51], v17 offset:16384
    v_mfma_f32_16x16x32_bf16 v[100:103], v[64:67], v[84:87], v[100:103]
    ds_read_b128 v[52:55], v19 offset:16384
    v_mfma_f32_16x16x32_bf16 v[104:107], v[68:71], v[80:83], v[104:107]
    ds_read_b64_tr_b16 v[32:33], v14 offset:20480
    v_mfma_f32_16x16x32_bf16 v[108:111], v[68:71], v[84:87], v[108:111]
    ds_read_b64_tr_b16 v[34:35], v14 offset:22528
    v_mfma_f32_16x16x32_bf16 v[124:127], v[80:83], v[80:83], v[124:127]
    ds_read_b64_tr_b16 v[36:37], v15 offset:20480
    v_mfma_f32_16x16x32_bf16 v[116:119], v[64:67], v[120:123], v[116:119]
    ds_read_b64_tr_b16 v[38:39], v15 offset:22528
    s_waitcnt lgkmcnt(13)
    v_mfma_f32_16x16x32_bf16 v[112:115], v[92:95], v[80:83], v[112:115]
    s_barrier
    s_waitcnt lgkmcnt(7)
    ds_read_b128 v[92:95], v20 offset:832
    v_mfma_f32_16x16x32_bf16 v[96:99], v[24:27], v[40:43], v[96:99]
    ds_read_b128 v[72:75], v16 offset:32768
    v_mfma_f32_16x16x32_bf16 v[100:103], v[24:27], v[44:47], v[100:103]
    ds_read_b128 v[76:79], v18 offset:32768
    v_mfma_f32_16x16x32_bf16 v[104:107], v[28:31], v[40:43], v[104:107]
    ds_read_b64_tr_b16 v[56:57], v14 offset:24576
    v_mfma_f32_16x16x32_bf16 v[108:111], v[28:31], v[44:47], v[108:111]
    ds_read_b64_tr_b16 v[58:59], v14 offset:26624
    v_mfma_f32_16x16x32_bf16 v[124:127], v[40:43], v[40:43], v[124:127]
    ds_read_b64_tr_b16 v[60:61], v15 offset:24576
    v_mfma_f32_16x16x32_bf16 v[116:119], v[24:27], v[120:123], v[116:119]
    ds_read_b64_tr_b16 v[62:63], v15 offset:26624
    s_waitcnt lgkmcnt(13)
    v_mfma_f32_16x16x32_bf16 v[112:115], v[88:91], v[40:43], v[112:115]
    s_waitcnt lgkmcnt(7)
    ds_read_b128 v[88:91], v20 offset:896
    v_mfma_f32_16x16x32_bf16 v[96:99], v[32:35], v[48:51], v[96:99]
    ds_read_b128 v[80:83], v17 offset:32768
    v_mfma_f32_16x16x32_bf16 v[100:103], v[32:35], v[52:55], v[100:103]
    ds_read_b128 v[84:87], v19 offset:32768
    v_mfma_f32_16x16x32_bf16 v[104:107], v[36:39], v[48:51], v[104:107]
    ds_read_b64_tr_b16 v[64:65], v14 offset:28672
    v_mfma_f32_16x16x32_bf16 v[108:111], v[36:39], v[52:55], v[108:111]
    ds_read_b64_tr_b16 v[66:67], v14 offset:30720
    v_mfma_f32_16x16x32_bf16 v[124:127], v[48:51], v[48:51], v[124:127]
    ds_read_b64_tr_b16 v[68:69], v15 offset:28672
    v_mfma_f32_16x16x32_bf16 v[116:119], v[32:35], v[120:123], v[116:119]
    ds_read_b64_tr_b16 v[70:71], v15 offset:30720
    s_waitcnt lgkmcnt(13)
    v_mfma_f32_16x16x32_bf16 v[112:115], v[92:95], v[48:51], v[112:115]
    s_barrier
    s_waitcnt lgkmcnt(7)
    ds_read_b128 v[92:95], v20 offset:960
    v_mfma_f32_16x16x32_bf16 v[96:99], v[56:59], v[72:75], v[96:99]
    ds_read_b128 v[40:43], v16 offset:49152
    v_mfma_f32_16x16x32_bf16 v[100:103], v[56:59], v[76:79], v[100:103]
    ds_read_b128 v[44:47], v18 offset:49152
    v_mfma_f32_16x16x32_bf16 v[104:107], v[60:63], v[72:75], v[104:107]
    ds_read_b64_tr_b16 v[24:25], v14 offset:32768
    v_mfma_f32_16x16x32_bf16 v[108:111], v[60:63], v[76:79], v[108:111]
    ds_read_b64_tr_b16 v[26:27], v14 offset:34816
    v_mfma_f32_16x16x32_bf16 v[124:127], v[72:75], v[72:75], v[124:127]
    ds_read_b64_tr_b16 v[28:29], v15 offset:32768
    v_mfma_f32_16x16x32_bf16 v[116:119], v[56:59], v[120:123], v[116:119]
    ds_read_b64_tr_b16 v[30:31], v15 offset:34816
    s_waitcnt lgkmcnt(13)
    v_mfma_f32_16x16x32_bf16 v[112:115], v[88:91], v[72:75], v[112:115]
    s_waitcnt lgkmcnt(7)
    ds_read_b128 v[88:91], v20 offset:1024
    v_mfma_f32_16x16x32_bf16 v[96:99], v[64:67], v[80:83], v[96:99]
    ds_read_b128 v[48:51], v17 offset:49152
    v_mfma_f32_16x16x32_bf16 v[100:103], v[64:67], v[84:87], v[100:103]
    ds_read_b128 v[52:55], v19 offset:49152
    v_mfma_f32_16x16x32_bf16 v[104:107], v[68:71], v[80:83], v[104:107]
    ds_read_b64_tr_b16 v[32:33], v14 offset:36864
    v_mfma_f32_16x16x32_bf16 v[108:111], v[68:71], v[84:87], v[108:111]
    ds_read_b64_tr_b16 v[34:35], v14 offset:38912
    v_mfma_f32_16x16x32_bf16 v[124:127], v[80:83], v[80:83], v[124:127]
    ds_read_b64_tr_b16 v[36:37], v15 offset:36864
    v_mfma_f32_16x16x32_bf16 v[116:119], v[64:67], v[120:123], v[116:119]
    ds_read_b64_tr_b16 v[38:39], v15 offset:38912
    s_waitcnt lgkmcnt(13)
    v_mfma_f32_16x16x32_bf16 v[112:115], v[92:95], v[80:83], v[112:115]
    s_waitcnt lgkmcnt(7)
    ds_read_b128 v[92:95], v20 offset:1088
    v_mfma_f32_16x16x32_bf16 v[96:99], v[24:27], v[40:43], v[96:99]
    v_mfma_f32_16x16x32_bf16 v[100:103], v[24:27], v[44:47], v[100:103]
    v_mfma_f32_16x16x32_bf16 v[104:107], v[28:31], v[40:43], v[104:107]
    v_mfma_f32_16x16x32_bf16 v[108:111], v[28:31], v[44:47], v[108:111]
    v_mfma_f32_16x16x32_bf16 v[124:127], v[40:43], v[40:43], v[124:127]
    v_mfma_f32_16x16x32_bf16 v[116:119], v[24:27], v[120:123], v[116:119]
    s_waitcnt lgkmcnt(7)
    v_mfma_f32_16x16x32_bf16 v[112:115], v[88:91], v[40:43], v[112:115]
    s_waitcnt lgkmcnt(1)
    v_mfma_f32_16x16x32_bf16 v[124:127], v[48:51], v[48:51], v[124:127]
    v_mfma_f32_16x16x32_bf16 v[116:119], v[32:35], v[120:123], v[116:119]
    s_waitcnt lgkmcnt(0)
    v_mfma_f32_16x16x32_bf16 v[112:115], v[92:95], v[48:51], v[112:115]
    v_mfma_f32_16x16x32_bf16 v[96:99], v[32:35], v[48:51], v[96:99]
    v_mfma_f32_16x16x32_bf16 v[100:103], v[32:35], v[52:55], v[100:103]
    v_mfma_f32_16x16x32_bf16 v[104:107], v[36:39], v[48:51], v[104:107]
    v_mfma_f32_16x16x32_bf16 v[108:111], v[36:39], v[52:55], v[108:111]
    s_nop 3
    v_cndmask_b32 v11, 0, v124, s[58:59]
    v_cndmask_b32 v11, v11, v125, s[46:47]
    v_cndmask_b32 v11, v11, v126, s[62:63]
    v_cndmask_b32 v124, v11, v127, s[50:51]
    s_mov_b64 exec, s[56:57]
    ds_write_b128 v13, v[116:119]
    s_mov_b64 exec, -1

    v_mov_b32 v10, v124
    s_nop 1
    v_permlane32_swap_b32 v124, v10
    s_nop 1
    v_add_f32 v124, v124, v10
    v_mov_b32 v10, v124
    s_nop 1
    v_permlane16_swap_b32 v124, v10
    s_nop 1
    v_add_f32 v124, v124, v10
    v_mov_b32 v21, v113
    v_mul_f32 v112, 0x3ae38e39, v112
    v_mul_f32 v124, 0x3ae38e39, v124
    v_fma_f32 v124, -v112, v112, v124
    v_max_f32 v124, 0, v124
    v_cvt_pk_bf16_f32 v56, v112, v112
    v_lshlrev_b32 v56, 16, v56
    v_xor_b32 v56, 0x80000000, v56
    v_cvt_pk_bf16_f32 v124, v124, v124
    v_lshlrev_b32 v124, 16, v124
    v_add_f32 v124, 0x3727c5ac, v124
    v_cvt_pk_bf16_f32 v124, v124, v124
    v_lshlrev_b32 v124, 16, v124
    v_sqrt_f32 v124, v124
    s_nop 0
    v_cvt_pk_bf16_f32 v59, v124, v124
    v_lshlrev_b32 v59, 16, v59
    v_rcp_f32 v10, v59
    s_nop 0
    v_mul_f32 v57, 0xc0135761, v10
    v_mul_f32 v58, v10, v10
    v_mul_f32 v58, v58, v57
    v_mul_f32 v58, 0x3d372713, v58
    s_mov_b64 exec, 0xffff
    ds_write_b128 v12, v[56:59]
    s_mov_b64 exec, -1
    v_xor_b32 v12, 256, v12
    v_xor_b32 v13, 64, v13

    s_waitcnt lgkmcnt(0)
    s_barrier
    ds_read_b128 v[60:63], v12
    ds_read_b128 v[120:123], v13
    v_fma_f32 v96, v56, v116, v96
    v_fma_f32 v97, v56, v117, v97
    v_fma_f32 v98, v56, v118, v98
    v_fma_f32 v99, v56, v119, v99
    v_mul_f32 v72, v96, v96
    v_mul_f32 v73, v97, v97
    v_mul_f32 v74, v98, v98
    v_mul_f32 v75, v99, v99
    v_fma_f32 v72, v72, v58, v57
    v_fma_f32 v73, v73, v58, v57
    v_fma_f32 v74, v74, v58, v57
    v_fma_f32 v75, v75, v58, v57
    v_mul_f32 v72, v96, v72
    v_mul_f32 v73, v97, v73
    v_mul_f32 v74, v98, v74
    v_mul_f32 v75, v99, v75
    v_exp_f32 v72, v72
    v_exp_f32 v73, v73
    v_exp_f32 v74, v74
    v_exp_f32 v75, v75
    v_fma_f32 v72, v72, v59, v59
    v_fma_f32 v73, v73, v59, v59
    v_fma_f32 v74, v74, v59, v59
    v_fma_f32 v75, v75, v59, v59
    v_rcp_f32 v72, v72
    v_rcp_f32 v73, v73
    v_rcp_f32 v74, v74
    v_rcp_f32 v75, v75
    v_mul_f32 v72, v96, v72
    v_mul_f32 v73, v97, v73
    v_mul_f32 v74, v98, v74
    v_mul_f32 v75, v99, v75
    v_cvt_pk_bf16_f32 v64, v72, v73
    v_cvt_pk_bf16_f32 v65, v74, v75
    s_waitcnt lgkmcnt(0)
    v_fma_f32 v100, v60, v116, v100
    v_fma_f32 v101, v60, v117, v101
    v_fma_f32 v102, v60, v118, v102
    v_fma_f32 v103, v60, v119, v103
    v_fma_f32 v104, v56, v120, v104
    v_fma_f32 v105, v56, v121, v105
    v_fma_f32 v106, v56, v122, v106
    v_fma_f32 v107, v56, v123, v107
    v_fma_f32 v108, v60, v120, v108
    v_fma_f32 v109, v60, v121, v109
    v_fma_f32 v110, v60, v122, v110
    v_fma_f32 v111, v60, v123, v111
    v_mul_f32 v76, v100, v100
    v_mul_f32 v77, v101, v101
    v_mul_f32 v78, v102, v102
    v_mul_f32 v79, v103, v103
    v_mul_f32 v80, v104, v104
    v_mul_f32 v81, v105, v105
    v_mul_f32 v82, v106, v106
    v_mul_f32 v83, v107, v107
    v_mul_f32 v84, v108, v108
    v_mul_f32 v85, v109, v109
    v_mul_f32 v86, v110, v110
    v_mul_f32 v87, v111, v111
    v_fma_f32 v76, v76, v62, v61
    v_fma_f32 v77, v77, v62, v61
    v_fma_f32 v78, v78, v62, v61
    v_fma_f32 v79, v79, v62, v61
    v_fma_f32 v80, v80, v58, v57
    v_fma_f32 v81, v81, v58, v57
    v_fma_f32 v82, v82, v58, v57
    v_fma_f32 v83, v83, v58, v57
    v_fma_f32 v84, v84, v62, v61
    v_fma_f32 v85, v85, v62, v61
    v_fma_f32 v86, v86, v62, v61
    v_fma_f32 v87, v87, v62, v61
    v_mul_f32 v76, v100, v76
    v_mul_f32 v77, v101, v77
    v_mul_f32 v78, v102, v78
    v_mul_f32 v79, v103, v79
    v_mul_f32 v80, v104, v80
    v_mul_f32 v81, v105, v81
    v_mul_f32 v82, v106, v82
    v_mul_f32 v83, v107, v83
    v_mul_f32 v84, v108, v84
    v_mul_f32 v85, v109, v85
    v_mul_f32 v86, v110, v86
    v_mul_f32 v87, v111, v87
    v_exp_f32 v76, v76
    v_exp_f32 v77, v77
    v_exp_f32 v78, v78
    v_exp_f32 v79, v79
    v_exp_f32 v80, v80
    v_exp_f32 v81, v81
    v_exp_f32 v82, v82
    v_exp_f32 v83, v83
    v_exp_f32 v84, v84
    v_exp_f32 v85, v85
    v_exp_f32 v86, v86
    v_exp_f32 v87, v87
    v_fma_f32 v76, v76, v63, v63
    v_fma_f32 v77, v77, v63, v63
    v_fma_f32 v78, v78, v63, v63
    v_fma_f32 v79, v79, v63, v63
    v_fma_f32 v80, v80, v59, v59
    v_fma_f32 v81, v81, v59, v59
    v_fma_f32 v82, v82, v59, v59
    v_fma_f32 v83, v83, v59, v59
    v_fma_f32 v84, v84, v63, v63
    v_fma_f32 v85, v85, v63, v63
    v_fma_f32 v86, v86, v63, v63
    v_fma_f32 v87, v87, v63, v63
    v_rcp_f32 v76, v76
    v_rcp_f32 v77, v77
    v_rcp_f32 v78, v78
    v_rcp_f32 v79, v79
    v_rcp_f32 v80, v80
    v_rcp_f32 v81, v81
    v_rcp_f32 v82, v82
    v_rcp_f32 v83, v83
    v_rcp_f32 v84, v84
    v_rcp_f32 v85, v85
    v_rcp_f32 v86, v86
    v_rcp_f32 v87, v87
    v_mul_f32 v76, v100, v76
    v_mul_f32 v77, v101, v77
    v_mul_f32 v78, v102, v78
    v_mul_f32 v79, v103, v79
    v_mul_f32 v80, v104, v80
    v_mul_f32 v81, v105, v81
    v_mul_f32 v82, v106, v82
    v_mul_f32 v83, v107, v83
    v_mul_f32 v84, v108, v84
    v_mul_f32 v85, v109, v85
    v_mul_f32 v86, v110, v86
    v_mul_f32 v87, v111, v87
    v_cvt_pk_bf16_f32 v66, v80, v81
    v_cvt_pk_bf16_f32 v67, v82, v83
    v_cvt_pk_bf16_f32 v68, v76, v77
    v_cvt_pk_bf16_f32 v69, v78, v79
    v_cvt_pk_bf16_f32 v70, v84, v85
    v_cvt_pk_bf16_f32 v71, v86, v87
    s_bitcmp0_b32 s54, 0
    s_cbranch_scc1 g1_nsw
    v_swap_b32 v64, v66
    v_swap_b32 v65, v67
    v_swap_b32 v68, v70
    v_swap_b32 v69, v71
    g1_nsw:
    s_cmp_eq_u32 s52, 4
    s_cselect_b32 s44, 18432, 0
    s_cmp_eq_u32 s52, 13
    s_cselect_b32 s44, 19456, s44
    s_cmp_eq_u32 s44, 0
    s_cbranch_scc1 g1_std
    v_add_u32 v6, s44, v4
    v_mov_b32 v72, 0
    v_mov_b32 v73, 0
    v_mov_b32 v74, v66
    v_mov_b32 v75, v67
    v_mov_b32 v76, 0
    v_mov_b32 v77, 0
    v_mov_b32 v78, v70
    v_mov_b32 v79, v71
    v_mov_b32 v66, 0
    v_mov_b32 v67, 0
    v_mov_b32 v70, 0
    v_mov_b32 v71, 0
    buffer_store_dwordx4 v[72:75], v6, s[24:27], s48 offen sc1
    buffer_store_dwordx4 v[76:79], v6, s[24:27], s49 offen sc1
    g1_std:
    buffer_store_dwordx4 v[64:67], v5, s[24:27], s48 offen sc1
    buffer_store_dwordx4 v[68:71], v5, s[24:27], s49 offen sc1

    s_lshl_b32 s44, s55, 1
    v_xor_b32 v11, s44, v23
    v_lshl_add_u32 v14, v11, 5, v22
    v_xor_b32 v11, 1, v11
    v_lshl_add_u32 v15, v11, 5, v22
    s_lshl_b32 s44, s39, 12
    v_lshrrev_b32 v12, 1, v3
    s_lshl_b32 s45, s55, 2
    v_add_u32 v12, s45, v12
    v_and_b32 v13, 7, v2
    v_xor_b32 v12, v12, v13
    v_lshlrev_b32 v13, 7, v2
    v_lshl_add_u32 v13, v12, 4, v13
    v_and_b32 v12, 1, v3
    v_lshl_add_u32 v13, v12, 3, v13
    v_add_u32 v17, s44, v13
    v_xor_b32 v18, 32, v17
    s_lshl_b32 s44, s39, 11
    s_add_u32 s44, s44, 73728
    v_lshl_add_u32 v13, v3, 8, s44

    v_add_u32 v12, 15, v2
    v_lshrrev_b32 v11, 4, v12
    v_and_b32 v12, 15, v12
    v_lshl_add_u32 v12, v12, 4, v13
    v_lshl_add_u32 v88, v11, 10, v12

    v_add_u32 v12, 1, v2
    v_lshrrev_b32 v11, 4, v12
    v_and_b32 v12, 15, v12
    v_lshl_add_u32 v12, v12, 4, v13
    v_lshl_add_u32 v89, v11, 10, v12

    v_add_u32 v12, 14, v2
    v_lshrrev_b32 v11, 4, v12
    v_and_b32 v12, 15, v12
    v_lshl_add_u32 v12, v12, 4, v13
    v_lshl_add_u32 v90, v11, 10, v12

    v_add_u32 v12, 2, v2
    v_lshrrev_b32 v11, 4, v12
    v_and_b32 v12, 15, v12
    v_lshl_add_u32 v12, v12, 4, v13
    v_lshl_add_u32 v91, v11, 10, v12

    s_waitcnt vmcnt(0)
    s_barrier
    s_cmp_lg_u32 s38, 1
    s_cbranch_scc1 g1_pub
    v_mov_b32 v10, s60
    v_mov_b32 v11, 1
    v_add_u32 v10, 0, v10
    s_mov_b64 exec, 1
    buffer_store_dword v11, v10, s[40:43], 0 offen sc1
    s_mov_b64 exec, -1
    g1_pub:

    s_cmp_lg_u32 s37, 0
    s_cbranch_scc1 nog_1
    v_cvt_pk_bf16_f32 v21, v21, v21
    v_lshlrev_b32 v21, 16, v21
    v_mul_f32 v21, 0xbfb8aa3b, v21
    v_exp_f32 v21, v21
    s_nop 0
    v_add_f32 v21, 1.0, v21
    v_rcp_f32 v21, v21
    s_nop 0
    v_cvt_pk_bf16_f32 v21, v21, v21
    v_lshlrev_b32 v21, 16, v21
    s_lshl_b32 s44, s38, 4
    s_add_u32 s44, s44, s61
    v_add_lshl_u32 v10, s44, v2, 2
    s_mov_b64 exec, 0xffff
    buffer_store_dword v21, v10, s[32:35], 0 offen sc1
    s_mov_b64 exec, -1
nog_1:
    s_add_u32 s24, s8, 2359296
    s_addc_u32 s25, s9, 0
    s_and_b32 s25, s25, 0xffff
    s_mov_b32 s26, 2359296
    s_mov_b32 s27, 0x20000
    s_add_u32 s20, s8, 7340032
    s_addc_u32 s21, s9, 0
    s_and_b32 s21, s21, 0xffff
    s_mov_b32 s22, 294912
    s_mov_b32 s23, 0x20000
    s_lshl_b32 s44, s36, 3
    s_lshl_b32 s45, s39, 1
    s_add_u32 s44, s44, s45
    s_mul_i32 s48, s44, 18432
    s_lshl_b32 s45, s37, 1
    s_add_u32 s45, s45, s55
    s_lshl_b32 s46, s45, 10
    s_add_u32 s48, s48, s46
    s_add_u32 s49, s48, 18432
    s_lshl_b32 s47, s45, 14
    s_lshl_b32 s44, s44, 4
    v_add_lshl_u32 v5, s44, v2, 3
    v_mov_b32 v120, 0x3f803f80
    s_cmp_lg_u32 s38, 0
    s_cbranch_scc1 g2_poll_ok
    v_min_u32 v12, 26, v0
    v_mul_u32_u24 v13, 7282, v12
    v_lshrrev_b32 v13, 16, v13
    v_mul_u32_u24 v10, 9, v13
    v_sub_u32 v12, v12, v10
    s_sub_u32 s44, s36, 1
    v_add_u32 v13, s44, v13
    v_max_i32 v13, 0, v13
    v_min_i32 v13, 15, v13
    v_lshlrev_b32 v13, 8, v13
    v_lshl_add_u32 v12, v12, 2, v13

g2_poll:
    buffer_load_dword v13, v12, s[40:43], 0 offen sc1
g2_poll_chk:
    s_waitcnt vmcnt(0)
    v_cmp_ne_u32 vcc, 1, v13
    s_cbranch_vccz g2_poll_ok
    s_sub_u32 s53, s53, 1
    s_cbranch_scc1 g2_poll_ok
    s_sleep 4
    s_branch g2_poll
g2_poll_ok:
    s_barrier
    s_barrier
    ds_read_b128 v[40:43], v88 offset:0
    ds_read_b128 v[44:47], v88 offset:1024
    ds_read_b64_tr_b16 v[24:25], v14 offset:0
    ds_read_b64_tr_b16 v[26:27], v14 offset:2048
    ds_read_b64_tr_b16 v[28:29], v15 offset:0
    ds_read_b64_tr_b16 v[30:31], v15 offset:2048
    ds_read_b128 v[48:51], v88 offset:9216
    ds_read_b128 v[52:55], v88 offset:10240
    ds_read_b64_tr_b16 v[32:33], v14 offset:4096
    ds_read_b64_tr_b16 v[34:35], v14 offset:6144
    ds_read_b64_tr_b16 v[36:37], v15 offset:4096
    ds_read_b64_tr_b16 v[38:39], v15 offset:6144
    s_waitcnt lgkmcnt(0)
    s_barrier
    v_mfma_f32_16x16x32_bf16 v[96:99], v[24:27], v[40:43], 0
    ds_read_b128 v[72:75], v88 offset:18432
    ds_read_b128 v[76:79], v88 offset:19456
    v_mfma_f32_16x16x32_bf16 v[100:103], v[24:27], v[44:47], 0
    ds_read_b64_tr_b16 v[56:57], v14 offset:8192
    ds_read_b64_tr_b16 v[58:59], v14 offset:10240
    v_mfma_f32_16x16x32_bf16 v[104:107], v[28:31], v[40:43], 0
    ds_read_b64_tr_b16 v[60:61], v15 offset:8192
    ds_read_b64_tr_b16 v[62:63], v15 offset:10240
    v_mfma_f32_16x16x32_bf16 v[108:111], v[28:31], v[44:47], 0
    ds_read_b128 v[80:83], v88 offset:27648
    ds_read_b128 v[84:87], v88 offset:28672
    v_mfma_f32_16x16x32_bf16 v[96:99], v[32:35], v[48:51], v[96:99]
    ds_read_b64_tr_b16 v[64:65], v14 offset:12288
    ds_read_b64_tr_b16 v[66:67], v14 offset:14336
    v_mfma_f32_16x16x32_bf16 v[100:103], v[32:35], v[52:55], v[100:103]
    ds_read_b64_tr_b16 v[68:69], v15 offset:12288
    ds_read_b64_tr_b16 v[70:71], v15 offset:14336
    v_mfma_f32_16x16x32_bf16 v[104:107], v[36:39], v[48:51], v[104:107]
    v_mfma_f32_16x16x32_bf16 v[108:111], v[36:39], v[52:55], v[108:111]
    s_waitcnt lgkmcnt(0)
    s_barrier
    v_mfma_f32_16x16x32_bf16 v[96:99], v[56:59], v[72:75], v[96:99]
    ds_read_b128 v[40:43], v88 offset:36864
    ds_read_b128 v[44:47], v88 offset:37888
    v_mfma_f32_16x16x32_bf16 v[100:103], v[56:59], v[76:79], v[100:103]
    ds_read_b64_tr_b16 v[24:25], v14 offset:16384
    ds_read_b64_tr_b16 v[26:27], v14 offset:18432
    v_mfma_f32_16x16x32_bf16 v[104:107], v[60:63], v[72:75], v[104:107]
    ds_read_b64_tr_b16 v[28:29], v15 offset:16384
    ds_read_b64_tr_b16 v[30:31], v15 offset:18432
    v_mfma_f32_16x16x32_bf16 v[108:111], v[60:63], v[76:79], v[108:111]
    ds_read_b128 v[48:51], v89 offset:46080
    ds_read_b128 v[52:55], v89 offset:47104
    v_mfma_f32_16x16x32_bf16 v[96:99], v[64:67], v[80:83], v[96:99]
    ds_read_b64_tr_b16 v[32:33], v14 offset:20480
    ds_read_b64_tr_b16 v[34:35], v14 offset:22528
    v_mfma_f32_16x16x32_bf16 v[100:103], v[64:67], v[84:87], v[100:103]
    ds_read_b64_tr_b16 v[36:37], v15 offset:20480
    ds_read_b64_tr_b16 v[38:39], v15 offset:22528
    v_mfma_f32_16x16x32_bf16 v[104:107], v[68:71], v[80:83], v[104:107]
    v_mfma_f32_16x16x32_bf16 v[108:111], v[68:71], v[84:87], v[108:111]
    s_waitcnt lgkmcnt(0)
    s_barrier
    v_mfma_f32_16x16x32_bf16 v[96:99], v[24:27], v[40:43], v[96:99]
    v_add_u32 v88, 0x2000, v88
    v_add_u32 v89, 0x2000, v89
    v_add_u32 v90, 0x2000, v90
    v_add_u32 v91, 0x2000, v91
    ds_read_b128 v[72:75], v89 offset:47104
    ds_read_b128 v[76:79], v89 offset:48128
    v_mfma_f32_16x16x32_bf16 v[100:103], v[24:27], v[44:47], v[100:103]
    ds_read_b64_tr_b16 v[56:57], v14 offset:24576
    ds_read_b64_tr_b16 v[58:59], v14 offset:26624
    v_mfma_f32_16x16x32_bf16 v[104:107], v[28:31], v[40:43], v[104:107]
    ds_read_b64_tr_b16 v[60:61], v15 offset:24576
    ds_read_b64_tr_b16 v[62:63], v15 offset:26624
    v_mfma_f32_16x16x32_bf16 v[108:111], v[28:31], v[44:47], v[108:111]
    ds_read_b128 v[80:83], v89 offset:56320
    ds_read_b128 v[84:87], v89 offset:57344
    v_mfma_f32_16x16x32_bf16 v[96:99], v[32:35], v[48:51], v[96:99]
    ds_read_b64_tr_b16 v[64:65], v14 offset:28672
    ds_read_b64_tr_b16 v[66:67], v14 offset:30720
    v_mfma_f32_16x16x32_bf16 v[100:103], v[32:35], v[52:55], v[100:103]
    ds_read_b64_tr_b16 v[68:69], v15 offset:28672
    ds_read_b64_tr_b16 v[70:71], v15 offset:30720
    v_mfma_f32_16x16x32_bf16 v[104:107], v[36:39], v[48:51], v[104:107]
    v_mfma_f32_16x16x32_bf16 v[108:111], v[36:39], v[52:55], v[108:111]
    s_waitcnt lgkmcnt(0)
    s_barrier
    v_mfma_f32_16x16x32_bf16 v[96:99], v[56:59], v[72:75], v[96:99]
    v_add_u32 v14, 0x8000, v14
    v_add_u32 v15, 0x8000, v15
    v_subrev_u32 v88, 0x2000, v88
    v_subrev_u32 v89, 0x2000, v89
    v_subrev_u32 v90, 0x2000, v90
    v_subrev_u32 v91, 0x2000, v91
    ds_read_b128 v[40:43], v89 offset:0
    ds_read_b128 v[44:47], v89 offset:1024
    v_mfma_f32_16x16x32_bf16 v[100:103], v[56:59], v[76:79], v[100:103]
    ds_read_b64_tr_b16 v[24:25], v14 offset:0
    ds_read_b64_tr_b16 v[26:27], v14 offset:2048
    v_mfma_f32_16x16x32_bf16 v[104:107], v[60:63], v[72:75], v[104:107]
    ds_read_b64_tr_b16 v[28:29], v15 offset:0
    ds_read_b64_tr_b16 v[30:31], v15 offset:2048
    v_mfma_f32_16x16x32_bf16 v[108:111], v[60:63], v[76:79], v[108:111]
    ds_read_b128 v[48:51], v90 offset:9216
    ds_read_b128 v[52:55], v90 offset:10240
    v_mfma_f32_16x16x32_bf16 v[96:99], v[64:67], v[80:83], v[96:99]
    ds_read_b64_tr_b16 v[32:33], v14 offset:4096
    ds_read_b64_tr_b16 v[34:35], v14 offset:6144
    v_mfma_f32_16x16x32_bf16 v[100:103], v[64:67], v[84:87], v[100:103]
    ds_read_b64_tr_b16 v[36:37], v15 offset:4096
    ds_read_b64_tr_b16 v[38:39], v15 offset:6144
    v_mfma_f32_16x16x32_bf16 v[104:107], v[68:71], v[80:83], v[104:107]
    v_mfma_f32_16x16x32_bf16 v[108:111], v[68:71], v[84:87], v[108:111]
    s_waitcnt lgkmcnt(0)
    s_barrier
    v_mfma_f32_16x16x32_bf16 v[96:99], v[24:27], v[40:43], v[96:99]
    ds_read_b128 v[72:75], v90 offset:18432
    ds_read_b128 v[76:79], v90 offset:19456
    v_mfma_f32_16x16x32_bf16 v[100:103], v[24:27], v[44:47], v[100:103]
    ds_read_b64_tr_b16 v[56:57], v14 offset:8192
    ds_read_b64_tr_b16 v[58:59], v14 offset:10240
    v_mfma_f32_16x16x32_bf16 v[104:107], v[28:31], v[40:43], v[104:107]
    ds_read_b64_tr_b16 v[60:61], v15 offset:8192
    ds_read_b64_tr_b16 v[62:63], v15 offset:10240
    v_mfma_f32_16x16x32_bf16 v[108:111], v[28:31], v[44:47], v[108:111]
    ds_read_b128 v[80:83], v90 offset:27648
    ds_read_b128 v[84:87], v90 offset:28672
    v_mfma_f32_16x16x32_bf16 v[96:99], v[32:35], v[48:51], v[96:99]
    ds_read_b64_tr_b16 v[64:65], v14 offset:12288
    ds_read_b64_tr_b16 v[66:67], v14 offset:14336
    v_mfma_f32_16x16x32_bf16 v[100:103], v[32:35], v[52:55], v[100:103]
    ds_read_b64_tr_b16 v[68:69], v15 offset:12288
    ds_read_b64_tr_b16 v[70:71], v15 offset:14336
    v_mfma_f32_16x16x32_bf16 v[104:107], v[36:39], v[48:51], v[104:107]
    v_mfma_f32_16x16x32_bf16 v[108:111], v[36:39], v[52:55], v[108:111]
    s_waitcnt lgkmcnt(0)
    s_barrier
    v_mfma_f32_16x16x32_bf16 v[96:99], v[56:59], v[72:75], v[96:99]
    ds_read_b128 v[40:43], v90 offset:36864
    ds_read_b128 v[44:47], v90 offset:37888
    v_mfma_f32_16x16x32_bf16 v[100:103], v[56:59], v[76:79], v[100:103]
    ds_read_b64_tr_b16 v[24:25], v14 offset:16384
    ds_read_b64_tr_b16 v[26:27], v14 offset:18432
    v_mfma_f32_16x16x32_bf16 v[104:107], v[60:63], v[72:75], v[104:107]
    ds_read_b64_tr_b16 v[28:29], v15 offset:16384
    ds_read_b64_tr_b16 v[30:31], v15 offset:18432
    v_mfma_f32_16x16x32_bf16 v[108:111], v[60:63], v[76:79], v[108:111]
    ds_read_b128 v[48:51], v90 offset:46080
    ds_read_b128 v[52:55], v90 offset:47104
    v_mfma_f32_16x16x32_bf16 v[96:99], v[64:67], v[80:83], v[96:99]
    ds_read_b64_tr_b16 v[32:33], v14 offset:20480
    ds_read_b64_tr_b16 v[34:35], v14 offset:22528
    v_mfma_f32_16x16x32_bf16 v[100:103], v[64:67], v[84:87], v[100:103]
    ds_read_b64_tr_b16 v[36:37], v15 offset:20480
    ds_read_b64_tr_b16 v[38:39], v15 offset:22528
    v_mfma_f32_16x16x32_bf16 v[104:107], v[68:71], v[80:83], v[104:107]
    v_mfma_f32_16x16x32_bf16 v[108:111], v[68:71], v[84:87], v[108:111]
    s_waitcnt lgkmcnt(0)
    s_barrier
    v_mfma_f32_16x16x32_bf16 v[96:99], v[24:27], v[40:43], v[96:99]
    v_add_u32 v88, 0x2000, v88
    v_add_u32 v89, 0x2000, v89
    v_add_u32 v90, 0x2000, v90
    v_add_u32 v91, 0x2000, v91
    ds_read_b128 v[72:75], v91 offset:47104
    ds_read_b128 v[76:79], v91 offset:48128
    v_mfma_f32_16x16x32_bf16 v[100:103], v[24:27], v[44:47], v[100:103]
    ds_read_b64_tr_b16 v[56:57], v14 offset:24576
    ds_read_b64_tr_b16 v[58:59], v14 offset:26624
    v_mfma_f32_16x16x32_bf16 v[104:107], v[28:31], v[40:43], v[104:107]
    ds_read_b64_tr_b16 v[60:61], v15 offset:24576
    ds_read_b64_tr_b16 v[62:63], v15 offset:26624
    v_mfma_f32_16x16x32_bf16 v[108:111], v[28:31], v[44:47], v[108:111]
    ds_read_b128 v[80:83], v91 offset:56320
    ds_read_b128 v[84:87], v91 offset:57344
    v_mfma_f32_16x16x32_bf16 v[96:99], v[32:35], v[48:51], v[96:99]
    ds_read_b64_tr_b16 v[64:65], v14 offset:28672
    ds_read_b64_tr_b16 v[66:67], v14 offset:30720
    v_mfma_f32_16x16x32_bf16 v[100:103], v[32:35], v[52:55], v[100:103]
    ds_read_b64_tr_b16 v[68:69], v15 offset:28672
    ds_read_b64_tr_b16 v[70:71], v15 offset:30720
    v_mfma_f32_16x16x32_bf16 v[104:107], v[36:39], v[48:51], v[104:107]
    v_mfma_f32_16x16x32_bf16 v[108:111], v[36:39], v[52:55], v[108:111]
    s_waitcnt lgkmcnt(0)
    s_barrier
    v_mfma_f32_16x16x32_bf16 v[96:99], v[56:59], v[72:75], v[96:99]
    v_subrev_u32 v88, 0x2000, v88
    v_subrev_u32 v89, 0x2000, v89
    v_subrev_u32 v90, 0x2000, v90
    v_subrev_u32 v91, 0x2000, v91
    ds_read_b128 v[40:43], v91 offset:0
    ds_read_b128 v[44:47], v91 offset:1024
    v_mfma_f32_16x16x32_bf16 v[100:103], v[56:59], v[76:79], v[100:103]
    ds_read_b64_tr_b16 v[24:25], v14 offset:32768
    ds_read_b64_tr_b16 v[26:27], v14 offset:34816
    v_mfma_f32_16x16x32_bf16 v[104:107], v[60:63], v[72:75], v[104:107]
    ds_read_b64_tr_b16 v[28:29], v15 offset:32768
    ds_read_b64_tr_b16 v[30:31], v15 offset:34816
    v_mfma_f32_16x16x32_bf16 v[108:111], v[60:63], v[76:79], v[108:111]
    ds_read_b128 v[48:51], v91 offset:9216
    ds_read_b128 v[52:55], v91 offset:10240
    v_mfma_f32_16x16x32_bf16 v[96:99], v[64:67], v[80:83], v[96:99]
    ds_read_b64_tr_b16 v[32:33], v14 offset:36864
    ds_read_b64_tr_b16 v[34:35], v14 offset:38912
    v_mfma_f32_16x16x32_bf16 v[100:103], v[64:67], v[84:87], v[100:103]
    ds_read_b64_tr_b16 v[36:37], v15 offset:36864
    ds_read_b64_tr_b16 v[38:39], v15 offset:38912
    v_mfma_f32_16x16x32_bf16 v[104:107], v[68:71], v[80:83], v[104:107]
    v_mfma_f32_16x16x32_bf16 v[108:111], v[68:71], v[84:87], v[108:111]
    s_waitcnt lgkmcnt(0)
    s_barrier
    v_mfma_f32_16x16x32_bf16 v[96:99], v[24:27], v[40:43], v[96:99]
    v_subrev_u32 v14, 0x8000, v14
    v_subrev_u32 v15, 0x8000, v15
    ds_read_b128 v[72:75], v89 offset:18432
    ds_read_b128 v[76:79], v89 offset:19456
    v_mfma_f32_16x16x32_bf16 v[100:103], v[24:27], v[44:47], v[100:103]
    ds_read_b64_tr_b16 v[56:57], v14 offset:16384
    ds_read_b64_tr_b16 v[58:59], v14 offset:18432
    v_mfma_f32_16x16x32_bf16 v[104:107], v[28:31], v[40:43], v[104:107]
    ds_read_b64_tr_b16 v[60:61], v15 offset:16384
    ds_read_b64_tr_b16 v[62:63], v15 offset:18432
    v_mfma_f32_16x16x32_bf16 v[108:111], v[28:31], v[44:47], v[108:111]
    ds_read_b128 v[80:83], v91 offset:27648
    ds_read_b128 v[84:87], v91 offset:28672
    v_mfma_f32_16x16x32_bf16 v[96:99], v[32:35], v[48:51], v[96:99]
    ds_read_b64_tr_b16 v[64:65], v14 offset:53248
    ds_read_b64_tr_b16 v[66:67], v14 offset:55296
    v_mfma_f32_16x16x32_bf16 v[100:103], v[32:35], v[52:55], v[100:103]
    ds_read_b64_tr_b16 v[68:69], v15 offset:53248
    ds_read_b64_tr_b16 v[70:71], v15 offset:55296
    v_mfma_f32_16x16x32_bf16 v[104:107], v[36:39], v[48:51], v[104:107]
    v_mfma_f32_16x16x32_bf16 v[108:111], v[36:39], v[52:55], v[108:111]
    s_waitcnt lgkmcnt(6)
    v_mfma_f32_16x16x32_bf16 v[96:99], v[56:59], v[72:75], v[96:99]
    v_mfma_f32_16x16x32_bf16 v[100:103], v[56:59], v[76:79], v[100:103]
    v_mfma_f32_16x16x32_bf16 v[104:107], v[60:63], v[72:75], v[104:107]
    v_mfma_f32_16x16x32_bf16 v[108:111], v[60:63], v[76:79], v[108:111]
    s_waitcnt lgkmcnt(0)
    v_mfma_f32_16x16x32_bf16 v[96:99], v[64:67], v[80:83], v[96:99]
    v_mfma_f32_16x16x32_bf16 v[100:103], v[64:67], v[84:87], v[100:103]
    v_mfma_f32_16x16x32_bf16 v[104:107], v[68:71], v[80:83], v[104:107]
    v_mfma_f32_16x16x32_bf16 v[108:111], v[68:71], v[84:87], v[108:111]
    ds_read_b64 v[24:25], v17 offset:0
    ds_read_b64 v[26:27], v18 offset:0
    ds_read_b64 v[28:29], v17 offset:2048
    ds_read_b64 v[30:31], v18 offset:2048
    s_nop 3
    v_cvt_pk_bf16_f32 v64, v96, v97
    v_cvt_pk_bf16_f32 v65, v98, v99
    v_cvt_pk_bf16_f32 v66, v100, v101
    v_cvt_pk_bf16_f32 v67, v102, v103
    v_cvt_pk_bf16_f32 v68, v104, v105
    v_cvt_pk_bf16_f32 v69, v106, v107
    v_cvt_pk_bf16_f32 v70, v108, v109
    v_cvt_pk_bf16_f32 v71, v110, v111
    s_waitcnt lgkmcnt(0)
    v_lshlrev_b32 v96, 16, v64
    v_and_b32 v97, 0xffff0000, v64
    v_lshlrev_b32 v98, 16, v65
    v_and_b32 v99, 0xffff0000, v65
    v_lshlrev_b32 v100, 16, v66
    v_and_b32 v101, 0xffff0000, v66
    v_lshlrev_b32 v102, 16, v67
    v_and_b32 v103, 0xffff0000, v67
    v_lshlrev_b32 v104, 16, v68
    v_and_b32 v105, 0xffff0000, v68
    v_lshlrev_b32 v106, 16, v69
    v_and_b32 v107, 0xffff0000, v69
    v_lshlrev_b32 v108, 16, v70
    v_and_b32 v109, 0xffff0000, v70
    v_lshlrev_b32 v110, 16, v71
    v_and_b32 v111, 0xffff0000, v71
    v_lshlrev_b32 v72, 16, v24
    v_and_b32 v73, 0xffff0000, v24
    v_lshlrev_b32 v74, 16, v25
    v_and_b32 v75, 0xffff0000, v25
    v_add_f32 v96, v96, v72
    v_add_f32 v97, v97, v73
    v_add_f32 v98, v98, v74
    v_add_f32 v99, v99, v75
    v_cvt_pk_bf16_f32 v80, v96, v97
    v_cvt_pk_bf16_f32 v81, v98, v99
    v_lshlrev_b32 v76, 16, v26
    v_and_b32 v77, 0xffff0000, v26
    v_lshlrev_b32 v78, 16, v27
    v_and_b32 v79, 0xffff0000, v27
    v_add_f32 v104, v104, v76
    v_add_f32 v105, v105, v77
    v_add_f32 v106, v106, v78
    v_add_f32 v107, v107, v79
    v_cvt_pk_bf16_f32 v82, v104, v105
    v_cvt_pk_bf16_f32 v83, v106, v107
    buffer_store_dwordx4 v[80:83], v4, s[24:27], s48 offen sc1
    v_lshlrev_b32 v72, 16, v28
    v_and_b32 v73, 0xffff0000, v28
    v_lshlrev_b32 v74, 16, v29
    v_and_b32 v75, 0xffff0000, v29
    v_add_f32 v100, v100, v72
    v_add_f32 v101, v101, v73
    v_add_f32 v102, v102, v74
    v_add_f32 v103, v103, v75
    v_cvt_pk_bf16_f32 v84, v100, v101
    v_cvt_pk_bf16_f32 v85, v102, v103
    v_lshlrev_b32 v76, 16, v30
    v_and_b32 v77, 0xffff0000, v30
    v_lshlrev_b32 v78, 16, v31
    v_and_b32 v79, 0xffff0000, v31
    v_add_f32 v108, v108, v76
    v_add_f32 v109, v109, v77
    v_add_f32 v110, v110, v78
    v_add_f32 v111, v111, v79
    v_cvt_pk_bf16_f32 v86, v108, v109
    v_cvt_pk_bf16_f32 v87, v110, v111
    buffer_store_dwordx4 v[84:87], v4, s[24:27], s49 offen sc1
    v_mov_b32 v88, 0
    v_mov_b32 v89, 0
    v_mov_b32 v90, 0
    v_mov_b32 v91, 0
    v_dot2c_f32_bf16 v88, v80, v120
    v_dot2c_f32_bf16 v89, v80, v80
    v_dot2c_f32_bf16 v90, v84, v120
    v_dot2c_f32_bf16 v91, v84, v84
    v_dot2c_f32_bf16 v88, v81, v120
    v_dot2c_f32_bf16 v89, v81, v81
    v_dot2c_f32_bf16 v90, v85, v120
    v_dot2c_f32_bf16 v91, v85, v85
    v_dot2c_f32_bf16 v88, v82, v120
    v_dot2c_f32_bf16 v89, v82, v82
    v_dot2c_f32_bf16 v90, v86, v120
    v_dot2c_f32_bf16 v91, v86, v86
    v_dot2c_f32_bf16 v88, v83, v120
    v_dot2c_f32_bf16 v89, v83, v83
    v_dot2c_f32_bf16 v90, v87, v120
    v_dot2c_f32_bf16 v91, v87, v87
    s_nop 2
    v_mov_b32 v92, v88
    v_mov_b32 v93, v89
    v_mov_b32 v94, v90
    v_mov_b32 v95, v91
    s_nop 0
    v_permlane32_swap_b32 v88, v92
    v_permlane32_swap_b32 v89, v93
    v_permlane32_swap_b32 v90, v94
    v_permlane32_swap_b32 v91, v95
    s_nop 0
    v_add_f32 v88, v88, v92
    v_add_f32 v89, v89, v93
    v_add_f32 v90, v90, v94
    v_add_f32 v91, v91, v95
    v_mov_b32 v92, v88
    v_mov_b32 v93, v89
    v_mov_b32 v94, v90
    v_mov_b32 v95, v91
    s_nop 0
    v_permlane16_swap_b32 v88, v92
    v_permlane16_swap_b32 v89, v93
    v_permlane16_swap_b32 v90, v94
    v_permlane16_swap_b32 v91, v95
    s_nop 0
    v_add_f32 v88, v88, v92
    v_add_f32 v89, v89, v93
    v_add_f32 v90, v90, v94
    v_add_f32 v91, v91, v95
    s_mov_b64 exec, 0xffff
    buffer_store_dwordx2 v[88:89], v5, s[20:23], s47 offen offset:0 sc1
    buffer_store_dwordx2 v[90:91], v5, s[20:23], s47 offen offset:128 sc1
    s_mov_b64 exec, -1
    s_waitcnt vmcnt(0)
    s_barrier
    s_cmp_lg_u32 s38, 1
    s_cbranch_scc1 g2_pub
    v_mov_b32 v10, s60
    v_mov_b32 v11, 1
    v_add_u32 v10, 6400, v10
    s_mov_b64 exec, 1
    buffer_store_dword v11, v10, s[40:43], 0 offen sc1
    s_mov_b64 exec, -1
    g2_pub:

    s_branch k3_entry
kf_side:
    s_cmp_lt_u32 s2, 216
    s_cbranch_scc1 kf_sd
    s_load_dwordx2 s[4:5], s[0:1], 72
    s_load_dwordx2 s[10:11], s[0:1], 112
    s_load_dwordx2 s[14:15], s[0:1], 104
    s_load_dwordx2 s[6:7], s[0:1], 64
    v_lshrrev_b32 v1, 8, v0
    v_and_b32 v6, 255, v0
    v_readfirstlane_b32 s38, v1
    v_lshrrev_b32 v1, 3, v6
    v_and_b32 v2, 7, v6
    v_mul_u32_u24 v3, 9216, v1
    v_lshl_add_u32 v3, v2, 4, v3
    s_sub_u32 s37, 255, s2
    s_mul_i32 s39, s37, 4
    s_add_u32 s39, s39, s38
    s_add_u32 s40, s37, 48
    s_cmp_ge_u32 s37, 16
    s_cselect_b32 s39, s40, s39
    s_cselect_b32 s40, 1, 4
    s_cmp_ge_u32 s39, 72
    s_cselect_b32 s40, 0, s40
    s_waitcnt lgkmcnt(0)
    s_cmp_lg_u32 s2, 216
    s_cbranch_scc1 cs_nz

    s_add_u32 s24, s10, 33554432
    s_addc_u32 s25, s11, 0
    s_and_b32 s25, s25, 0xffff
    s_mov_b32 s26, 12288
    s_mov_b32 s27, 0x20000
    s_add_u32 s32, s10, 12189696
    s_addc_u32 s33, s11, 0
    s_and_b32 s33, s33, 0xffff
    s_mov_b32 s34, 13312
    s_mov_b32 s35, 0x20000
    s_mov_b32 s28, s14
    s_and_b32 s29, s15, 0xffff
    s_mov_b32 s30, 256
    s_mov_b32 s31, 0x20000
    v_mov_b32 v88, 0
    v_mov_b32 v89, 0
    v_mov_b32 v90, 0
    v_mov_b32 v91, 0
    v_lshlrev_b32 v94, 4, v0
    buffer_store_dwordx4 v[88:91], v94, s[32:35], 0 offen sc1
    buffer_store_dwordx4 v[88:91], v94, s[24:27], 0 offen sc1
    s_mov_b32 s41, 0

    s_waitcnt vmcnt(0)
    s_barrier
    s_cmp_lg_u32 s101, 0
    s_cbranch_scc1 cs_nz
    v_mov_b32 v10, s41
    v_mov_b32 v11, 1
    v_add_u32 v10, 0, v10
    s_mov_b64 exec, 1
    buffer_store_dword v11, v10, s[28:31], 0 offen sc1
    s_mov_b64 exec, -1
    cs_nz:

    s_cmp_lt_u32 s38, s40
    s_cbranch_scc1 cs_go

    s_cmp_lt_u32 s37, 16
    s_cbranch_scc1 cs_npf
    s_sub_u32 s41, s2, 216
    s_lshl_b32 s41, s41, 2
    s_add_u32 s41, s41, s101
    s_sub_u32 s41, s41, 12
    s_cmp_lt_u32 s101, 12
    s_cbranch_scc1 cs_npf
    s_lshl_b32 s41, s41, 13
    v_and_b32 v4, 63, v0
    v_lshlrev_b32 v4, 7, v4

    s_mov_b32 s16, s6
    s_and_b32 s17, s7, 0xffff
    s_mov_b32 s18, 663552
    s_mov_b32 s19, 0x20000
    buffer_load_dword v100, v4, s[16:19], s41 offen
    cs_npf:

    s_barrier
    s_branch cs_end
    cs_go:

    s_mov_b32 s16, s4
    s_and_b32 s17, s5, 0xffff
    s_mov_b32 s18, 5308416
    s_mov_b32 s19, 0x20000
    s_add_u32 s20, s10, 12124160
    s_addc_u32 s21, s11, 0
    s_and_b32 s21, s21, 0xffff
    s_mov_b32 s22, 18432
    s_mov_b32 s23, 0x20000
    s_min_u32 s36, s39, 71
    s_lshl_b32 s36, s36, 7
    s_cmp_ge_u32 s39, 72
    s_cselect_b32 s18, 0, s18

    buffer_load_dwordx4 v[16:19], v3, s[16:19], s36 offen
    s_add_u32 s36, s36, 294912
    buffer_load_dwordx4 v[20:23], v3, s[16:19], s36 offen
    s_add_u32 s36, s36, 294912
    buffer_load_dwordx4 v[24:27], v3, s[16:19], s36 offen
    s_add_u32 s36, s36, 294912
    buffer_load_dwordx4 v[28:31], v3, s[16:19], s36 offen
    s_add_u32 s36, s36, 294912
    buffer_load_dwordx4 v[32:35], v3, s[16:19], s36 offen
    s_add_u32 s36, s36, 294912
    buffer_load_dwordx4 v[36:39], v3, s[16:19], s36 offen
    s_add_u32 s36, s36, 294912
    buffer_load_dwordx4 v[40:43], v3, s[16:19], s36 offen
    s_add_u32 s36, s36, 294912
    buffer_load_dwordx4 v[44:47], v3, s[16:19], s36 offen
    s_add_u32 s36, s36, 294912
    buffer_load_dwordx4 v[48:51], v3, s[16:19], s36 offen
    s_add_u32 s36, s36, 294912
    buffer_load_dwordx4 v[52:55], v3, s[16:19], s36 offen
    s_add_u32 s36, s36, 294912
    buffer_load_dwordx4 v[56:59], v3, s[16:19], s36 offen
    s_add_u32 s36, s36, 294912
    buffer_load_dwordx4 v[60:63], v3, s[16:19], s36 offen
    s_add_u32 s36, s36, 294912
    buffer_load_dwordx4 v[64:67], v3, s[16:19], s36 offen
    s_add_u32 s36, s36, 294912
    buffer_load_dwordx4 v[68:71], v3, s[16:19], s36 offen
    s_add_u32 s36, s36, 294912
    buffer_load_dwordx4 v[72:75], v3, s[16:19], s36 offen
    s_add_u32 s36, s36, 294912
    buffer_load_dwordx4 v[76:79], v3, s[16:19], s36 offen
    s_add_u32 s36, s36, 294912
    buffer_load_dwordx4 v[80:83], v3, s[16:19], s36 offen
    s_add_u32 s36, s36, 294912
    buffer_load_dwordx4 v[84:87], v3, s[16:19], s36 offen
    s_add_u32 s36, s36, 294912
    s_lshl_b32 s40, s38, 13
    s_add_u32 s40, s40, 127872
    v_lshl_add_u32 v7, v6, 5, s40
    v_lshl_add_u32 v93, v6, 2, s40
    v_lshlrev_b32 v94, 2, v6

    s_waitcnt vmcnt(17)
    v_lshlrev_b32 v8, 16, v16
    v_and_b32 v9, 0xffff0000, v16
    v_lshlrev_b32 v10, 16, v17
    v_and_b32 v11, 0xffff0000, v17
    v_lshlrev_b32 v12, 16, v18
    v_and_b32 v13, 0xffff0000, v18
    v_lshlrev_b32 v14, 16, v19
    v_and_b32 v15, 0xffff0000, v19
    s_waitcnt vmcnt(16)
    v_lshlrev_b32 v4, 16, v20
    v_and_b32 v5, 0xffff0000, v20
    v_add_f32 v8, v8, v4
    v_add_f32 v9, v9, v5
    v_lshlrev_b32 v4, 16, v21
    v_and_b32 v5, 0xffff0000, v21
    v_add_f32 v10, v10, v4
    v_add_f32 v11, v11, v5
    v_lshlrev_b32 v4, 16, v22
    v_and_b32 v5, 0xffff0000, v22
    v_add_f32 v12, v12, v4
    v_add_f32 v13, v13, v5
    v_lshlrev_b32 v4, 16, v23
    v_and_b32 v5, 0xffff0000, v23
    v_add_f32 v14, v14, v4
    v_add_f32 v15, v15, v5
    s_waitcnt vmcnt(15)
    v_lshlrev_b32 v4, 16, v24
    v_and_b32 v5, 0xffff0000, v24
    v_add_f32 v8, v8, v4
    v_add_f32 v9, v9, v5
    v_lshlrev_b32 v4, 16, v25
    v_and_b32 v5, 0xffff0000, v25
    v_add_f32 v10, v10, v4
    v_add_f32 v11, v11, v5
    v_lshlrev_b32 v4, 16, v26
    v_and_b32 v5, 0xffff0000, v26
    v_add_f32 v12, v12, v4
    v_add_f32 v13, v13, v5
    v_lshlrev_b32 v4, 16, v27
    v_and_b32 v5, 0xffff0000, v27
    v_add_f32 v14, v14, v4
    v_add_f32 v15, v15, v5
    s_waitcnt vmcnt(14)
    v_lshlrev_b32 v4, 16, v28
    v_and_b32 v5, 0xffff0000, v28
    v_add_f32 v8, v8, v4
    v_add_f32 v9, v9, v5
    v_lshlrev_b32 v4, 16, v29
    v_and_b32 v5, 0xffff0000, v29
    v_add_f32 v10, v10, v4
    v_add_f32 v11, v11, v5
    v_lshlrev_b32 v4, 16, v30
    v_and_b32 v5, 0xffff0000, v30
    v_add_f32 v12, v12, v4
    v_add_f32 v13, v13, v5
    v_lshlrev_b32 v4, 16, v31
    v_and_b32 v5, 0xffff0000, v31
    v_add_f32 v14, v14, v4
    v_add_f32 v15, v15, v5
    s_waitcnt vmcnt(13)
    v_lshlrev_b32 v4, 16, v32
    v_and_b32 v5, 0xffff0000, v32
    v_add_f32 v8, v8, v4
    v_add_f32 v9, v9, v5
    v_lshlrev_b32 v4, 16, v33
    v_and_b32 v5, 0xffff0000, v33
    v_add_f32 v10, v10, v4
    v_add_f32 v11, v11, v5
    v_lshlrev_b32 v4, 16, v34
    v_and_b32 v5, 0xffff0000, v34
    v_add_f32 v12, v12, v4
    v_add_f32 v13, v13, v5
    v_lshlrev_b32 v4, 16, v35
    v_and_b32 v5, 0xffff0000, v35
    v_add_f32 v14, v14, v4
    v_add_f32 v15, v15, v5
    s_waitcnt vmcnt(12)
    v_lshlrev_b32 v4, 16, v36
    v_and_b32 v5, 0xffff0000, v36
    v_add_f32 v8, v8, v4
    v_add_f32 v9, v9, v5
    v_lshlrev_b32 v4, 16, v37
    v_and_b32 v5, 0xffff0000, v37
    v_add_f32 v10, v10, v4
    v_add_f32 v11, v11, v5
    v_lshlrev_b32 v4, 16, v38
    v_and_b32 v5, 0xffff0000, v38
    v_add_f32 v12, v12, v4
    v_add_f32 v13, v13, v5
    v_lshlrev_b32 v4, 16, v39
    v_and_b32 v5, 0xffff0000, v39
    v_add_f32 v14, v14, v4
    v_add_f32 v15, v15, v5
    s_waitcnt vmcnt(11)
    v_lshlrev_b32 v4, 16, v40
    v_and_b32 v5, 0xffff0000, v40
    v_add_f32 v8, v8, v4
    v_add_f32 v9, v9, v5
    v_lshlrev_b32 v4, 16, v41
    v_and_b32 v5, 0xffff0000, v41
    v_add_f32 v10, v10, v4
    v_add_f32 v11, v11, v5
    v_lshlrev_b32 v4, 16, v42
    v_and_b32 v5, 0xffff0000, v42
    v_add_f32 v12, v12, v4
    v_add_f32 v13, v13, v5
    v_lshlrev_b32 v4, 16, v43
    v_and_b32 v5, 0xffff0000, v43
    v_add_f32 v14, v14, v4
    v_add_f32 v15, v15, v5
    s_waitcnt vmcnt(10)
    v_lshlrev_b32 v4, 16, v44
    v_and_b32 v5, 0xffff0000, v44
    v_add_f32 v8, v8, v4
    v_add_f32 v9, v9, v5
    v_lshlrev_b32 v4, 16, v45
    v_and_b32 v5, 0xffff0000, v45
    v_add_f32 v10, v10, v4
    v_add_f32 v11, v11, v5
    v_lshlrev_b32 v4, 16, v46
    v_and_b32 v5, 0xffff0000, v46
    v_add_f32 v12, v12, v4
    v_add_f32 v13, v13, v5
    v_lshlrev_b32 v4, 16, v47
    v_and_b32 v5, 0xffff0000, v47
    v_add_f32 v14, v14, v4
    v_add_f32 v15, v15, v5
    s_waitcnt vmcnt(9)
    v_lshlrev_b32 v4, 16, v48
    v_and_b32 v5, 0xffff0000, v48
    v_add_f32 v8, v8, v4
    v_add_f32 v9, v9, v5
    v_lshlrev_b32 v4, 16, v49
    v_and_b32 v5, 0xffff0000, v49
    v_add_f32 v10, v10, v4
    v_add_f32 v11, v11, v5
    v_lshlrev_b32 v4, 16, v50
    v_and_b32 v5, 0xffff0000, v50
    v_add_f32 v12, v12, v4
    v_add_f32 v13, v13, v5
    v_lshlrev_b32 v4, 16, v51
    v_and_b32 v5, 0xffff0000, v51
    v_add_f32 v14, v14, v4
    v_add_f32 v15, v15, v5
    s_waitcnt vmcnt(8)
    v_lshlrev_b32 v4, 16, v52
    v_and_b32 v5, 0xffff0000, v52
    v_add_f32 v8, v8, v4
    v_add_f32 v9, v9, v5
    v_lshlrev_b32 v4, 16, v53
    v_and_b32 v5, 0xffff0000, v53
    v_add_f32 v10, v10, v4
    v_add_f32 v11, v11, v5
    v_lshlrev_b32 v4, 16, v54
    v_and_b32 v5, 0xffff0000, v54
    v_add_f32 v12, v12, v4
    v_add_f32 v13, v13, v5
    v_lshlrev_b32 v4, 16, v55
    v_and_b32 v5, 0xffff0000, v55
    v_add_f32 v14, v14, v4
    v_add_f32 v15, v15, v5
    s_waitcnt vmcnt(7)
    v_lshlrev_b32 v4, 16, v56
    v_and_b32 v5, 0xffff0000, v56
    v_add_f32 v8, v8, v4
    v_add_f32 v9, v9, v5
    v_lshlrev_b32 v4, 16, v57
    v_and_b32 v5, 0xffff0000, v57
    v_add_f32 v10, v10, v4
    v_add_f32 v11, v11, v5
    v_lshlrev_b32 v4, 16, v58
    v_and_b32 v5, 0xffff0000, v58
    v_add_f32 v12, v12, v4
    v_add_f32 v13, v13, v5
    v_lshlrev_b32 v4, 16, v59
    v_and_b32 v5, 0xffff0000, v59
    v_add_f32 v14, v14, v4
    v_add_f32 v15, v15, v5
    s_waitcnt vmcnt(6)
    v_lshlrev_b32 v4, 16, v60
    v_and_b32 v5, 0xffff0000, v60
    v_add_f32 v8, v8, v4
    v_add_f32 v9, v9, v5
    v_lshlrev_b32 v4, 16, v61
    v_and_b32 v5, 0xffff0000, v61
    v_add_f32 v10, v10, v4
    v_add_f32 v11, v11, v5
    v_lshlrev_b32 v4, 16, v62
    v_and_b32 v5, 0xffff0000, v62
    v_add_f32 v12, v12, v4
    v_add_f32 v13, v13, v5
    v_lshlrev_b32 v4, 16, v63
    v_and_b32 v5, 0xffff0000, v63
    v_add_f32 v14, v14, v4
    v_add_f32 v15, v15, v5
    s_waitcnt vmcnt(5)
    v_lshlrev_b32 v4, 16, v64
    v_and_b32 v5, 0xffff0000, v64
    v_add_f32 v8, v8, v4
    v_add_f32 v9, v9, v5
    v_lshlrev_b32 v4, 16, v65
    v_and_b32 v5, 0xffff0000, v65
    v_add_f32 v10, v10, v4
    v_add_f32 v11, v11, v5
    v_lshlrev_b32 v4, 16, v66
    v_and_b32 v5, 0xffff0000, v66
    v_add_f32 v12, v12, v4
    v_add_f32 v13, v13, v5
    v_lshlrev_b32 v4, 16, v67
    v_and_b32 v5, 0xffff0000, v67
    v_add_f32 v14, v14, v4
    v_add_f32 v15, v15, v5
    s_waitcnt vmcnt(4)
    v_lshlrev_b32 v4, 16, v68
    v_and_b32 v5, 0xffff0000, v68
    v_add_f32 v8, v8, v4
    v_add_f32 v9, v9, v5
    v_lshlrev_b32 v4, 16, v69
    v_and_b32 v5, 0xffff0000, v69
    v_add_f32 v10, v10, v4
    v_add_f32 v11, v11, v5
    v_lshlrev_b32 v4, 16, v70
    v_and_b32 v5, 0xffff0000, v70
    v_add_f32 v12, v12, v4
    v_add_f32 v13, v13, v5
    v_lshlrev_b32 v4, 16, v71
    v_and_b32 v5, 0xffff0000, v71
    v_add_f32 v14, v14, v4
    v_add_f32 v15, v15, v5
    s_waitcnt vmcnt(3)
    v_lshlrev_b32 v4, 16, v72
    v_and_b32 v5, 0xffff0000, v72
    v_add_f32 v8, v8, v4
    v_add_f32 v9, v9, v5
    v_lshlrev_b32 v4, 16, v73
    v_and_b32 v5, 0xffff0000, v73
    v_add_f32 v10, v10, v4
    v_add_f32 v11, v11, v5
    v_lshlrev_b32 v4, 16, v74
    v_and_b32 v5, 0xffff0000, v74
    v_add_f32 v12, v12, v4
    v_add_f32 v13, v13, v5
    v_lshlrev_b32 v4, 16, v75
    v_and_b32 v5, 0xffff0000, v75
    v_add_f32 v14, v14, v4
    v_add_f32 v15, v15, v5
    s_waitcnt vmcnt(2)
    v_lshlrev_b32 v4, 16, v76
    v_and_b32 v5, 0xffff0000, v76
    v_add_f32 v8, v8, v4
    v_add_f32 v9, v9, v5
    v_lshlrev_b32 v4, 16, v77
    v_and_b32 v5, 0xffff0000, v77
    v_add_f32 v10, v10, v4
    v_add_f32 v11, v11, v5
    v_lshlrev_b32 v4, 16, v78
    v_and_b32 v5, 0xffff0000, v78
    v_add_f32 v12, v12, v4
    v_add_f32 v13, v13, v5
    v_lshlrev_b32 v4, 16, v79
    v_and_b32 v5, 0xffff0000, v79
    v_add_f32 v14, v14, v4
    v_add_f32 v15, v15, v5
    s_waitcnt vmcnt(1)
    v_lshlrev_b32 v4, 16, v80
    v_and_b32 v5, 0xffff0000, v80
    v_add_f32 v8, v8, v4
    v_add_f32 v9, v9, v5
    v_lshlrev_b32 v4, 16, v81
    v_and_b32 v5, 0xffff0000, v81
    v_add_f32 v10, v10, v4
    v_add_f32 v11, v11, v5
    v_lshlrev_b32 v4, 16, v82
    v_and_b32 v5, 0xffff0000, v82
    v_add_f32 v12, v12, v4
    v_add_f32 v13, v13, v5
    v_lshlrev_b32 v4, 16, v83
    v_and_b32 v5, 0xffff0000, v83
    v_add_f32 v14, v14, v4
    v_add_f32 v15, v15, v5
    s_waitcnt vmcnt(0)
    v_lshlrev_b32 v4, 16, v84
    v_and_b32 v5, 0xffff0000, v84
    v_add_f32 v8, v8, v4
    v_add_f32 v9, v9, v5
    v_lshlrev_b32 v4, 16, v85
    v_and_b32 v5, 0xffff0000, v85
    v_add_f32 v10, v10, v4
    v_add_f32 v11, v11, v5
    v_lshlrev_b32 v4, 16, v86
    v_and_b32 v5, 0xffff0000, v86
    v_add_f32 v12, v12, v4
    v_add_f32 v13, v13, v5
    v_lshlrev_b32 v4, 16, v87
    v_and_b32 v5, 0xffff0000, v87
    v_add_f32 v14, v14, v4
    v_add_f32 v15, v15, v5
    ds_write_b128 v7, v[8:11]
    ds_write_b128 v7, v[12:15] offset:16
    s_waitcnt lgkmcnt(0)
    s_barrier
    v_cmp_gt_u32 vcc, 64, v6
    s_and_saveexec_b64 s[52:53], vcc
    s_cbranch_execz cs_ns

    ds_read_b32 v16, v93 offset:0
    ds_read_b32 v17, v93 offset:256
    ds_read_b32 v18, v93 offset:512
    ds_read_b32 v19, v93 offset:768
    ds_read_b32 v20, v93 offset:1024
    ds_read_b32 v21, v93 offset:1280
    ds_read_b32 v22, v93 offset:1536
    ds_read_b32 v23, v93 offset:1792
    s_waitcnt lgkmcnt(0)
    ds_read_b32 v24, v93 offset:2048
    ds_read_b32 v25, v93 offset:2304
    ds_read_b32 v26, v93 offset:2560
    ds_read_b32 v27, v93 offset:2816
    ds_read_b32 v28, v93 offset:3072
    ds_read_b32 v29, v93 offset:3328
    ds_read_b32 v30, v93 offset:3584
    ds_read_b32 v31, v93 offset:3840
    s_waitcnt lgkmcnt(0)
    ds_read_b32 v32, v93 offset:4096
    ds_read_b32 v33, v93 offset:4352
    ds_read_b32 v34, v93 offset:4608
    ds_read_b32 v35, v93 offset:4864
    ds_read_b32 v36, v93 offset:5120
    ds_read_b32 v37, v93 offset:5376
    ds_read_b32 v38, v93 offset:5632
    ds_read_b32 v39, v93 offset:5888
    s_waitcnt lgkmcnt(0)
    ds_read_b32 v40, v93 offset:6144
    ds_read_b32 v41, v93 offset:6400
    ds_read_b32 v42, v93 offset:6656
    ds_read_b32 v43, v93 offset:6912
    ds_read_b32 v44, v93 offset:7168
    ds_read_b32 v45, v93 offset:7424
    ds_read_b32 v46, v93 offset:7680
    ds_read_b32 v47, v93 offset:7936
    s_waitcnt lgkmcnt(0)
    v_add_f32 v16, v16, v17
    v_add_f32 v16, v16, v18
    v_add_f32 v16, v16, v19
    v_add_f32 v16, v16, v20
    v_add_f32 v16, v16, v21
    v_add_f32 v16, v16, v22
    v_add_f32 v16, v16, v23
    v_add_f32 v16, v16, v24
    v_add_f32 v16, v16, v25
    v_add_f32 v16, v16, v26
    v_add_f32 v16, v16, v27
    v_add_f32 v16, v16, v28
    v_add_f32 v16, v16, v29
    v_add_f32 v16, v16, v30
    v_add_f32 v16, v16, v31
    v_add_f32 v16, v16, v32
    v_add_f32 v16, v16, v33
    v_add_f32 v16, v16, v34
    v_add_f32 v16, v16, v35
    v_add_f32 v16, v16, v36
    v_add_f32 v16, v16, v37
    v_add_f32 v16, v16, v38
    v_add_f32 v16, v16, v39
    v_add_f32 v16, v16, v40
    v_add_f32 v16, v16, v41
    v_add_f32 v16, v16, v42
    v_add_f32 v16, v16, v43
    v_add_f32 v16, v16, v44
    v_add_f32 v16, v16, v45
    v_add_f32 v16, v16, v46
    v_add_f32 v16, v16, v47
    s_lshl_b32 s36, s39, 8
    buffer_store_dword v16, v94, s[20:23], s36 offen sc1

    s_mov_b32 s28, s14
    s_and_b32 s29, s15, 0xffff
    s_mov_b32 s30, 256
    s_mov_b32 s31, 0x20000
    s_add_u32 s32, s10, 12189696
    s_addc_u32 s33, s11, 0
    s_and_b32 s33, s33, 0xffff
    s_mov_b32 s34, 13312
    s_mov_b32 s35, 0x20000
    v_mov_b32 v17, 0
    s_mov_b32 s54, 0x8000
c_val:
    buffer_load_dword v18, v17, s[28:31], 0 offen sc1
c_val_chk:
    s_waitcnt vmcnt(0)
    v_cmp_ne_u32 vcc, 1, v18
    s_cbranch_vccz c_val_ok
    s_sub_u32 s54, s54, 1
    s_cbranch_scc1 c_val_ok
    s_sleep 8
    s_branch c_val
c_val_ok:
    s_mul_i32 s41, s39, 7282
    s_lshr_b32 s41, s41, 16
    s_mul_i32 s42, s41, 9
    s_sub_u32 s42, s39, s42
    s_lshl_b32 s41, s41, 8
    s_lshl_b32 s42, s42, 2
    s_add_u32 s41, s41, s42
    s_add_u32 s41, s41, 10496
    v_mov_b32 v18, 1
    s_mov_b64 exec, 1
    buffer_store_dword v18, v17, s[32:35], s41 offen sc1

    cs_ns:
    s_mov_b64 exec, s[52:53]
    cs_end:
    s_cmp_lt_u32 s2, 240
    s_cbranch_scc1 kf_sd

    s_barrier
    s_branch k3_entry
kf_sd:
    s_sub_u32 s3, s2, 144
    s_load_dwordx2 s[4:5], s[0:1], 8
    s_load_dwordx2 s[6:7], s[0:1], 16
    s_load_dwordx2 s[8:9], s[0:1], 24
    s_load_dwordx2 s[10:11], s[0:1], 112
    s_load_dwordx2 s[12:13], s[0:1], 32
    s_load_dwordx2 s[14:15], s[0:1], 104
    s_load_dwordx2 s[56:57], s[0:1], 40
    s_load_dwordx2 s[58:59], s[0:1], 56
    s_load_dwordx2 s[60:61], s[0:1], 0
    s_load_dwordx2 s[62:63], s[0:1], 64
    v_lshrrev_b32 v1, 6, v0
    v_and_b32 v0, 63, v0
    v_readfirstlane_b32 s38, v1
    v_and_b32 v2, 15, v0
    v_lshrrev_b32 v3, 4, v0
    s_mov_b32 s53, 0x8000
    v_mov_b32 v10, 163000
    v_mov_b32 v11, 0
    ds_write2_b32 v10, v11, v11 offset0:0 offset1:1
    s_waitcnt lgkmcnt(0)

    s_add_u32 s28, s10, 4718592
    s_addc_u32 s29, s11, 0
    s_and_b32 s29, s29, 0xffff
    s_mov_b32 s30, 2359312
    s_mov_b32 s31, 0x20000
    s_mov_b32 s40, s14
    s_and_b32 s41, s15, 0xffff
    s_mov_b32 s42, 256
    s_mov_b32 s43, 0x20000
    v_mov_b32 v126, 0
    s_cmp_ge_u32 s3, 72
    s_cbranch_scc1 sd_nop
    s_mul_i32 s37, s3, 7282
    s_lshr_b32 s37, s37, 16
    s_mul_i32 s39, s37, 9
    s_sub_u32 s39, s3, s39
    s_add_u32 s52, s39, 16
    s_lshl_b32 s52, s52, 8
    s_lshl_b32 s48, s37, 2
    s_add_u32 s52, s52, s48
    s_lshl_b32 s48, s37, 4
    s_add_u32 s48, s48, s38
    s_lshl_b32 s48, s48, 4
    v_lshrrev_b32 v13, 5, v0
    v_and_b32 v14, 31, v0
    v_lshl_add_u32 v4, v13, 3, s48
    s_lshl_b32 s49, s39, 6
    v_lshl_add_u32 v5, v14, 1, s49
    v_mul_u32_u24 v6, 1152, v4
    v_lshl_add_u32 v7, v5, 1, v6
    v_subrev_u32 v6, 4608, v7
    v_add_u32 v8, 4608, v7
    v_lshlrev_b32 v9, 3, v5

    s_mov_b32 s16, s4
    s_and_b32 s17, s5, 0xffff
    s_mov_b32 s18, 2359296
    s_mov_b32 s19, 0x20000
    s_mov_b32 s24, s8
    s_and_b32 s25, s9, 0xffff
    s_mov_b32 s26, 4608
    s_mov_b32 s27, 0x20000
    buffer_load_dwordx4 v[36:39], v9, s[24:27], 0 offen
    buffer_load_dword v17, v6, s[16:19], 0 offen offset:1152 nt
    buffer_load_dword v18, v6, s[16:19], 0 offen offset:2304 nt
    buffer_load_dword v19, v6, s[16:19], 0 offen offset:3456 nt
    buffer_load_dword v20, v7, s[16:19], 0 offen offset:0 nt
    buffer_load_dword v21, v7, s[16:19], 0 offen offset:1152 nt
    buffer_load_dword v22, v7, s[16:19], 0 offen offset:2304 nt
    buffer_load_dword v23, v7, s[16:19], 0 offen offset:3456 nt
    buffer_load_dword v24, v8, s[16:19], 0 offen offset:0 nt
    buffer_load_dword v25, v8, s[16:19], 0 offen offset:1152 nt
    buffer_load_dword v26, v8, s[16:19], 0 offen offset:2304 nt
    buffer_load_dword v27, v8, s[16:19], 0 offen offset:3456 nt
    s_mov_b32 s20, s6
    s_and_b32 s21, s7, 0xffff
    s_mov_b32 s22, 2359296
    s_mov_b32 s23, 0x20000
    buffer_load_dword v28, v7, s[20:23], 0 offen offset:0 nt
    buffer_load_dword v29, v7, s[20:23], 0 offen offset:1152 nt
    buffer_load_dword v30, v7, s[20:23], 0 offen offset:2304 nt
    buffer_load_dword v31, v7, s[20:23], 0 offen offset:3456 nt
    buffer_load_dword v32, v8, s[20:23], 0 offen offset:0 nt
    buffer_load_dword v33, v8, s[20:23], 0 offen offset:1152 nt
    buffer_load_dword v34, v8, s[20:23], 0 offen offset:2304 nt
    buffer_load_dword v35, v8, s[20:23], 0 offen offset:3456 nt
    v_mul_u32_u24 v12, 1056, v14
    v_and_b32 v11, 255, v4
    v_sub_u32 v11, 248, v11
    v_lshl_add_u32 v12, v11, 1, v12
    v_add_u32 v12, 127872, v12
    s_lshl_b32 s50, s38, 2
    v_add_u32 v13, s50, v13
    v_mul_u32_u24 v15, 528, v13
    v_lshl_add_u32 v15, v14, 4, v15
    v_add_u32 v15, 127872, v15
    v_lshlrev_b32 v13, 12, v13
    v_lshl_add_u32 v13, v14, 4, v13
    s_lshl_b32 s50, s39, 18
    s_sub_u32 s51, 7, s37
    s_lshl_b32 s51, s51, 9
    s_add_u32 s50, s50, s51

    s_waitcnt vmcnt(8)
    v_lshlrev_b32 v41, 16, v17
    v_lshlrev_b32 v42, 16, v18
    v_lshlrev_b32 v43, 16, v19
    v_lshlrev_b32 v44, 16, v20
    v_lshlrev_b32 v45, 16, v21
    v_lshlrev_b32 v46, 16, v22
    v_lshlrev_b32 v47, 16, v23
    v_lshlrev_b32 v48, 16, v24
    v_lshlrev_b32 v49, 16, v25
    v_lshlrev_b32 v50, 16, v26
    v_lshlrev_b32 v51, 16, v27
    v_lshlrev_b32 v52, 16, v36
    v_and_b32 v53, 0xffff0000, v36
    v_lshlrev_b32 v54, 16, v37
    v_and_b32 v55, 0xffff0000, v37
    v_mul_f32 v56, v41, v55
    v_mul_f32 v57, v42, v55
    v_mul_f32 v58, v43, v55
    v_mul_f32 v59, v44, v55
    v_mul_f32 v60, v45, v55
    v_mul_f32 v61, v46, v55
    v_mul_f32 v62, v47, v55
    v_mul_f32 v63, v48, v55
    v_fma_f32 v56, v42, v54, v56
    v_fma_f32 v57, v43, v54, v57
    v_fma_f32 v58, v44, v54, v58
    v_fma_f32 v59, v45, v54, v59
    v_fma_f32 v60, v46, v54, v60
    v_fma_f32 v61, v47, v54, v61
    v_fma_f32 v62, v48, v54, v62
    v_fma_f32 v63, v49, v54, v63
    v_fma_f32 v56, v43, v53, v56
    v_fma_f32 v57, v44, v53, v57
    v_fma_f32 v58, v45, v53, v58
    v_fma_f32 v59, v46, v53, v59
    v_fma_f32 v60, v47, v53, v60
    v_fma_f32 v61, v48, v53, v61
    v_fma_f32 v62, v49, v53, v62
    v_fma_f32 v63, v50, v53, v63
    v_fma_f32 v56, v44, v52, v56
    v_fma_f32 v57, v45, v52, v57
    v_fma_f32 v58, v46, v52, v58
    v_fma_f32 v59, v47, v52, v59
    v_fma_f32 v60, v48, v52, v60
    v_fma_f32 v61, v49, v52, v61
    v_fma_f32 v62, v50, v52, v62
    v_fma_f32 v63, v51, v52, v63
    v_and_b32 v41, 0xffff0000, v17
    v_and_b32 v42, 0xffff0000, v18
    v_and_b32 v43, 0xffff0000, v19
    v_and_b32 v44, 0xffff0000, v20
    v_and_b32 v45, 0xffff0000, v21
    v_and_b32 v46, 0xffff0000, v22
    v_and_b32 v47, 0xffff0000, v23
    v_and_b32 v48, 0xffff0000, v24
    v_and_b32 v49, 0xffff0000, v25
    v_and_b32 v50, 0xffff0000, v26
    v_and_b32 v51, 0xffff0000, v27
    v_lshlrev_b32 v52, 16, v38
    v_and_b32 v53, 0xffff0000, v38
    v_lshlrev_b32 v54, 16, v39
    v_and_b32 v55, 0xffff0000, v39
    v_mul_f32 v64, v41, v55
    v_mul_f32 v65, v42, v55
    v_mul_f32 v66, v43, v55
    v_mul_f32 v67, v44, v55
    v_mul_f32 v68, v45, v55
    v_mul_f32 v69, v46, v55
    v_mul_f32 v70, v47, v55
    v_mul_f32 v71, v48, v55
    v_fma_f32 v64, v42, v54, v64
    v_fma_f32 v65, v43, v54, v65
    v_fma_f32 v66, v44, v54, v66
    v_fma_f32 v67, v45, v54, v67
    v_fma_f32 v68, v46, v54, v68
    v_fma_f32 v69, v47, v54, v69
    v_fma_f32 v70, v48, v54, v70
    v_fma_f32 v71, v49, v54, v71
    v_fma_f32 v64, v43, v53, v64
    v_fma_f32 v65, v44, v53, v65
    v_fma_f32 v66, v45, v53, v66
    v_fma_f32 v67, v46, v53, v67
    v_fma_f32 v68, v47, v53, v68
    v_fma_f32 v69, v48, v53, v69
    v_fma_f32 v70, v49, v53, v70
    v_fma_f32 v71, v50, v53, v71
    v_fma_f32 v64, v44, v52, v64
    v_fma_f32 v65, v45, v52, v65
    v_fma_f32 v66, v46, v52, v66
    v_fma_f32 v67, v47, v52, v67
    v_fma_f32 v68, v48, v52, v68
    v_fma_f32 v69, v49, v52, v69
    v_fma_f32 v70, v50, v52, v70
    v_fma_f32 v71, v51, v52, v71
    s_waitcnt vmcnt(0)
    s_cmp_lg_u32 s38, 0
    s_cbranch_scc1 nv_2
    buffer_load_dword v127, v126, s[40:43], 0 offen sc1
nv_2:
    v_lshlrev_b32 v72, 16, v28
    v_lshlrev_b32 v73, 16, v29
    v_lshlrev_b32 v74, 16, v30
    v_lshlrev_b32 v75, 16, v31
    v_lshlrev_b32 v76, 16, v32
    v_lshlrev_b32 v77, 16, v33
    v_lshlrev_b32 v78, 16, v34
    v_lshlrev_b32 v79, 16, v35
    v_mul_f32 v56, v56, v72
    v_mul_f32 v57, v57, v73
    v_mul_f32 v58, v58, v74
    v_mul_f32 v59, v59, v75
    v_mul_f32 v60, v60, v76
    v_mul_f32 v61, v61, v77
    v_mul_f32 v62, v62, v78
    v_mul_f32 v63, v63, v79
    v_cvt_pk_bf16_f32 v80, v63, v62
    v_cvt_pk_bf16_f32 v81, v61, v60
    v_cvt_pk_bf16_f32 v82, v59, v58
    v_cvt_pk_bf16_f32 v83, v57, v56
    ds_write_b128 v12, v[80:83] offset:0
    v_and_b32 v72, 0xffff0000, v28
    v_and_b32 v73, 0xffff0000, v29
    v_and_b32 v74, 0xffff0000, v30
    v_and_b32 v75, 0xffff0000, v31
    v_and_b32 v76, 0xffff0000, v32
    v_and_b32 v77, 0xffff0000, v33
    v_and_b32 v78, 0xffff0000, v34
    v_and_b32 v79, 0xffff0000, v35
    v_mul_f32 v64, v64, v72
    v_mul_f32 v65, v65, v73
    v_mul_f32 v66, v66, v74
    v_mul_f32 v67, v67, v75
    v_mul_f32 v68, v68, v76
    v_mul_f32 v69, v69, v77
    v_mul_f32 v70, v70, v78
    v_mul_f32 v71, v71, v79
    v_cvt_pk_bf16_f32 v84, v71, v70
    v_cvt_pk_bf16_f32 v85, v69, v68
    v_cvt_pk_bf16_f32 v86, v67, v66
    v_cvt_pk_bf16_f32 v87, v65, v64
    ds_write_b128 v12, v[84:87] offset:528
    s_waitcnt lgkmcnt(0)
    s_barrier
    ds_read_b128 v[16:19], v15 offset:0
    ds_read_b128 v[20:23], v15 offset:1056
    s_waitcnt lgkmcnt(1)
    buffer_store_dwordx4 v[16:19], v13, s[28:31], s50 offen sc1
    s_add_u32 s50, s50, 8192
    s_waitcnt lgkmcnt(0)
    buffer_store_dwordx4 v[20:23], v13, s[28:31], s50 offen sc1
    s_add_u32 s50, s50, 8192
    s_cmp_lg_u32 s38, 0
    s_cbranch_scc1 p_val_ok
    s_branch p_val_chk
p_val:
    buffer_load_dword v127, v126, s[40:43], 0 offen sc1
p_val_chk:
    s_waitcnt vmcnt(0)
    v_cmp_ne_u32 vcc, 1, v127
    s_cbranch_vccz p_val_ok
    s_sub_u32 s53, s53, 1
    s_cbranch_scc1 p_val_ok
    s_sleep 4
    s_branch p_val
p_val_ok:
    s_add_u32 s40, s10, 12189696
    s_addc_u32 s41, s11, 0
    s_and_b32 s41, s41, 0xffff
    s_mov_b32 s42, 13312
    s_mov_b32 s43, 0x20000
    s_waitcnt vmcnt(0)
    s_barrier
    s_cmp_lg_u32 s38, 0
    s_cbranch_scc1 pr_pub
    v_mov_b32 v10, s52
    v_mov_b32 v11, 1
    v_add_u32 v10, 0, v10
    s_mov_b64 exec, 1
    buffer_store_dword v11, v10, s[40:43], 0 offen sc1
    s_mov_b64 exec, -1
    pr_pub:

    s_branch sd_conv
sd_nop:
    s_cmp_lg_u32 s38, 0
    s_cbranch_scc1 s_val_ok
s_val:
    buffer_load_dword v127, v126, s[40:43], 0 offen sc1
s_val_chk:
    s_waitcnt vmcnt(0)
    v_cmp_ne_u32 vcc, 1, v127
    s_cbranch_vccz s_val_ok
    s_sub_u32 s53, s53, 1
    s_cbranch_scc1 s_val_ok
    s_sleep 8
    s_branch s_val
s_val_ok:
sd_conv:
    s_cmp_lt_u32 s38, 12
    s_cbranch_scc1 sd_act
    s_load_dwordx2 s[62:63], s[0:1], 80
    s_barrier
    s_barrier
    s_barrier
    s_barrier
    s_barrier
    s_barrier
    s_barrier
    s_branch k3_entry
sd_act:
    s_lshr_b32 s36, s38, 1
    s_and_b32 s37, s38, 1
    s_mul_i32 s39, s36, 21312
    s_mul_i32 s48, s3, 6
    s_add_u32 s48, s48, s36
    s_and_b32 s49, s48, 0xfffe
    s_lshl_b32 s49, s49, 1
    s_load_dword s54, s[56:57], s49
    v_lshlrev_b32 v4, 4, v0
    s_lshl_b32 s50, s48, 12
    s_lshl_b32 s51, s37, 11
    s_add_u32 s49, s50, s51
    s_add_u32 s51, s51, s39

    s_mov_b32 s32, s12
    s_and_b32 s33, s13, 0xffff
    s_mov_b32 s34, 2359296
    s_mov_b32 s35, 0x20000
    s_add_u32 m0, s51, 17152
    s_nop 0
    buffer_load_dwordx4 v4, s[32:35], s49 offen offset:0 nt lds
    buffer_load_dwordx4 v4, s[32:35], s49 offen offset:1024 nt lds
cv_hs:
    s_add_u32 s44, s10, 9437184
    s_addc_u32 s45, s11, 0
    s_and_b32 s45, s45, 0xffff
    s_mov_b32 s46, 2359296
    s_mov_b32 s47, 0x20000
    v_mov_b32 v8, 0
    v_mov_b32 v9, 0
    v_mov_b32 v10, 0
    v_mov_b32 v11, 0
    v_add_u32 v5, s39, v4
    s_mov_b32 exec_hi, 0xf
    ds_write_b128 v5, v[8:11] offset:16576
    s_mov_b64 exec, 0xf
    ds_write_b128 v5, v[8:11] offset:4096
    ds_write_b128 v5, v[8:11] offset:8256
    ds_write_b128 v5, v[8:11] offset:12416
    s_mov_b64 exec, -1
    v_lshrrev_b32 v5, 2, v2
    v_sub_u32 v5, 3, v5
    v_lshl_add_u32 v5, v3, 1, v5
    v_lshlrev_b32 v5, 3, v5
    v_and_b32 v6, 3, v2
    v_xor_b32 v6, 3, v6
    v_mul_u32_u24 v6, 4160, v6
    s_xor_b32 s49, s37, 1
    s_lshl_b32 s49, s49, 8
    s_add_u32 s49, s49, s39
    v_add3_u32 v12, v5, v6, s49
    v_lshlrev_b32 v5, 5, v2
    v_lshl_add_u32 v5, v3, 4, v5
    v_add_u32 v7, s49, v5
    v_add_u32 v7, 16672, v7
    s_mul_i32 s49, s3, 6
    v_bfe_u32 v6, v0, 3, 1
    v_mul_u32_u24 v6, 5, v6
    v_add_u32 v6, s49, v6
    v_lshrrev_b32 v6, 6, v6
    v_add_u32 v6, 16, v6
    v_lshlrev_b32 v6, 8, v6
    v_and_b32 v5, 7, v0
    v_lshl_add_u32 v6, v5, 2, v6
    s_lshl_b32 s49, s37, 11
    s_add_u32 s50, s50, s49
    s_add_u32 s51, s49, s39

    s_add_u32 s40, s10, 12189696
    s_addc_u32 s41, s11, 0
    s_and_b32 s41, s41, 0xffff
    s_mov_b32 s42, 13312
    s_mov_b32 s43, 0x20000
    s_cmp_lg_u32 s38, 0
    s_cbranch_scc1 cv_poll_ok
cv_poll:
    buffer_load_dword v5, v6, s[40:43], 0 offen sc1
cv_poll_chk:
    s_waitcnt vmcnt(0)
    v_cmp_ne_u32 vcc, 1, v5
    s_cbranch_vccz cv_poll_ok
    s_sub_u32 s53, s53, 1
    s_cbranch_scc1 cv_poll_ok
    s_sleep 6
    s_branch cv_poll
cv_poll_ok:
    s_barrier
    s_mov_b32 m0, s51
    s_nop 0
    buffer_load_dwordx4 v4, s[28:31], s50 offen offset:0 sc1 lds
    buffer_load_dwordx4 v4, s[28:31], s50 offen offset:1024 sc1 lds
    v_add_u32 v5, s51, v4
    s_waitcnt vmcnt(0) lgkmcnt(0)
    s_barrier
    ds_read_b128 v[16:19], v5
    ds_read_b64 v[20:21], v5 offset:16
    ds_read_b128 v[24:27], v5 offset:1024
    ds_read_b64 v[28:29], v5 offset:1040

    s_waitcnt lgkmcnt(2)
    v_alignbit_b32 v32, v17, v16, 16
    v_alignbit_b32 v33, v18, v17, 16
    v_alignbit_b32 v34, v19, v18, 16
    v_alignbit_b32 v35, v20, v19, 16
    ds_write_b128 v5, v[32:35] offset:4160
    v_mov_b32 v36, v17
    v_mov_b32 v37, v18
    v_mov_b32 v38, v19
    v_mov_b32 v39, v20
    ds_write_b128 v5, v[36:39] offset:8320
    v_alignbit_b32 v40, v18, v17, 16
    v_alignbit_b32 v41, v19, v18, 16
    v_alignbit_b32 v42, v20, v19, 16
    v_alignbit_b32 v43, v21, v20, 16
    ds_write_b128 v5, v[40:43] offset:12480
    s_waitcnt lgkmcnt(3)
    v_alignbit_b32 v44, v25, v24, 16
    v_alignbit_b32 v45, v26, v25, 16
    v_alignbit_b32 v46, v27, v26, 16
    v_alignbit_b32 v47, v28, v27, 16
    ds_write_b128 v5, v[44:47] offset:5184
    v_mov_b32 v48, v25
    v_mov_b32 v49, v26
    v_mov_b32 v50, v27
    v_mov_b32 v51, v28
    ds_write_b128 v5, v[48:51] offset:9344
    v_alignbit_b32 v52, v26, v25, 16
    v_alignbit_b32 v53, v27, v26, 16
    v_alignbit_b32 v54, v28, v27, 16
    v_alignbit_b32 v55, v29, v28, 16
    ds_write_b128 v5, v[52:55] offset:13504
    s_waitcnt lgkmcnt(0)
    s_barrier
    ds_read_b64 v[48:49], v12 offset:3776
    ds_read_b64 v[50:51], v12 offset:3784
    ds_read_b128 v[80:83], v7 offset:192
    ds_read_b64 v[52:53], v12 offset:3264
    ds_read_b64 v[54:55], v12 offset:3272
    ds_read_b128 v[84:87], v7 offset:704
    ds_read_b64 v[56:57], v12 offset:2752
    ds_read_b64 v[58:59], v12 offset:2760
    ds_read_b128 v[88:91], v7 offset:1216
    ds_read_b64 v[60:61], v12 offset:2240
    ds_read_b64 v[62:63], v12 offset:2248
    ds_read_b128 v[92:95], v7 offset:1728
    s_waitcnt lgkmcnt(9)
    v_mfma_f32_16x16x32_bf16 v[16:19], v[48:51], v[80:83], 0
    ds_read_b64 v[64:65], v12 offset:1728
    s_waitcnt lgkmcnt(7)
    v_mfma_f32_16x16x32_bf16 v[20:23], v[48:51], v[84:87], 0
    ds_read_b64 v[66:67], v12 offset:1736
    v_mfma_f32_16x16x32_bf16 v[20:23], v[52:55], v[80:83], v[20:23]
    ds_read_b128 v[96:99], v7 offset:2240
    s_waitcnt lgkmcnt(6)
    v_mfma_f32_16x16x32_bf16 v[24:27], v[48:51], v[88:91], 0
    ds_read_b64 v[68:69], v12 offset:1216
    v_mfma_f32_16x16x32_bf16 v[24:27], v[52:55], v[84:87], v[24:27]
    ds_read_b64 v[70:71], v12 offset:1224
    v_mfma_f32_16x16x32_bf16 v[24:27], v[56:59], v[80:83], v[24:27]
    ds_read_b128 v[100:103], v7 offset:2752
    s_waitcnt lgkmcnt(6)
    v_mfma_f32_16x16x32_bf16 v[28:31], v[48:51], v[92:95], 0
    ds_read_b64 v[72:73], v12 offset:704
    v_mfma_f32_16x16x32_bf16 v[28:31], v[52:55], v[88:91], v[28:31]
    ds_read_b64 v[74:75], v12 offset:712
    v_mfma_f32_16x16x32_bf16 v[28:31], v[56:59], v[84:87], v[28:31]
    ds_read_b128 v[104:107], v7 offset:3264
    v_mfma_f32_16x16x32_bf16 v[28:31], v[60:63], v[80:83], v[28:31]
    ds_read_b64 v[76:77], v12 offset:192
    s_waitcnt lgkmcnt(7)
    v_mfma_f32_16x16x32_bf16 v[32:35], v[48:51], v[96:99], 0
    ds_read_b64 v[78:79], v12 offset:200
    v_mfma_f32_16x16x32_bf16 v[32:35], v[52:55], v[92:95], v[32:35]
    ds_read_b128 v[108:111], v7 offset:3776
    v_mfma_f32_16x16x32_bf16 v[32:35], v[56:59], v[88:91], v[32:35]
    ds_read_b64 v[112:113], v12 offset:3712
    v_mfma_f32_16x16x32_bf16 v[32:35], v[60:63], v[84:87], v[32:35]
    ds_read_b64 v[114:115], v12 offset:3720
    v_mfma_f32_16x16x32_bf16 v[32:35], v[64:67], v[80:83], v[32:35]
    ds_read_b128 v[120:123], v7 offset:128
    s_waitcnt lgkmcnt(9)
    v_mfma_f32_16x16x32_bf16 v[36:39], v[48:51], v[100:103], 0
    ds_read_b64 v[116:117], v12 offset:3200
    v_mfma_f32_16x16x32_bf16 v[36:39], v[52:55], v[96:99], v[36:39]
    ds_read_b64 v[118:119], v12 offset:3208
    v_mfma_f32_16x16x32_bf16 v[36:39], v[56:59], v[92:95], v[36:39]
    ds_read_b128 v[124:127], v7 offset:640
    v_mfma_f32_16x16x32_bf16 v[36:39], v[60:63], v[88:91], v[36:39]
    v_mfma_f32_16x16x32_bf16 v[36:39], v[64:67], v[84:87], v[36:39]
    v_mfma_f32_16x16x32_bf16 v[36:39], v[68:71], v[80:83], v[36:39]
    s_waitcnt lgkmcnt(9)
    v_mfma_f32_16x16x32_bf16 v[40:43], v[48:51], v[104:107], 0
    v_mfma_f32_16x16x32_bf16 v[40:43], v[52:55], v[100:103], v[40:43]
    v_mfma_f32_16x16x32_bf16 v[40:43], v[56:59], v[96:99], v[40:43]
    v_mfma_f32_16x16x32_bf16 v[40:43], v[60:63], v[92:95], v[40:43]
    v_mfma_f32_16x16x32_bf16 v[40:43], v[64:67], v[88:91], v[40:43]
    v_mfma_f32_16x16x32_bf16 v[40:43], v[68:71], v[84:87], v[40:43]
    v_mfma_f32_16x16x32_bf16 v[40:43], v[72:75], v[80:83], v[40:43]
    s_waitcnt lgkmcnt(6)
    v_mfma_f32_16x16x32_bf16 v[44:47], v[48:51], v[108:111], 0
    v_mfma_f32_16x16x32_bf16 v[44:47], v[52:55], v[104:107], v[44:47]
    v_mfma_f32_16x16x32_bf16 v[44:47], v[56:59], v[100:103], v[44:47]
    v_mfma_f32_16x16x32_bf16 v[44:47], v[60:63], v[96:99], v[44:47]
    v_mfma_f32_16x16x32_bf16 v[44:47], v[64:67], v[92:95], v[44:47]
    v_mfma_f32_16x16x32_bf16 v[44:47], v[68:71], v[88:91], v[44:47]
    v_mfma_f32_16x16x32_bf16 v[44:47], v[72:75], v[84:87], v[44:47]
    v_mfma_f32_16x16x32_bf16 v[44:47], v[76:79], v[80:83], v[44:47]
    s_waitcnt lgkmcnt(3)
    v_mfma_f32_16x16x32_bf16 v[16:19], v[112:115], v[120:123], v[16:19]
    ds_read_b64 v[56:57], v12 offset:2688
    s_waitcnt lgkmcnt(1)
    v_mfma_f32_16x16x32_bf16 v[20:23], v[112:115], v[124:127], v[20:23]
    ds_read_b64 v[58:59], v12 offset:2696
    v_mfma_f32_16x16x32_bf16 v[20:23], v[116:119], v[120:123], v[20:23]
    ds_read_b128 v[88:91], v7 offset:1152
    s_waitcnt lgkmcnt(0)
    v_mfma_f32_16x16x32_bf16 v[24:27], v[112:115], v[88:91], v[24:27]
    ds_read_b64 v[60:61], v12 offset:2176
    v_mfma_f32_16x16x32_bf16 v[24:27], v[116:119], v[124:127], v[24:27]
    ds_read_b64 v[62:63], v12 offset:2184
    v_mfma_f32_16x16x32_bf16 v[24:27], v[56:59], v[120:123], v[24:27]
    ds_read_b128 v[92:95], v7 offset:1664
    s_waitcnt lgkmcnt(0)
    v_mfma_f32_16x16x32_bf16 v[28:31], v[112:115], v[92:95], v[28:31]
    ds_read_b64 v[64:65], v12 offset:1664
    v_mfma_f32_16x16x32_bf16 v[28:31], v[116:119], v[88:91], v[28:31]
    ds_read_b64 v[66:67], v12 offset:1672
    v_mfma_f32_16x16x32_bf16 v[28:31], v[56:59], v[124:127], v[28:31]
    ds_read_b128 v[96:99], v7 offset:2176
    v_mfma_f32_16x16x32_bf16 v[28:31], v[60:63], v[120:123], v[28:31]
    ds_read_b64 v[68:69], v12 offset:1152
    s_waitcnt lgkmcnt(1)
    v_mfma_f32_16x16x32_bf16 v[32:35], v[112:115], v[96:99], v[32:35]
    ds_read_b64 v[70:71], v12 offset:1160
    v_mfma_f32_16x16x32_bf16 v[32:35], v[116:119], v[92:95], v[32:35]
    ds_read_b128 v[100:103], v7 offset:2688
    v_mfma_f32_16x16x32_bf16 v[32:35], v[56:59], v[88:91], v[32:35]
    ds_read_b64 v[72:73], v12 offset:640
    v_mfma_f32_16x16x32_bf16 v[32:35], v[60:63], v[124:127], v[32:35]
    ds_read_b64 v[74:75], v12 offset:648
    v_mfma_f32_16x16x32_bf16 v[32:35], v[64:67], v[120:123], v[32:35]
    ds_read_b128 v[104:107], v7 offset:3200
    s_waitcnt lgkmcnt(3)
    v_mfma_f32_16x16x32_bf16 v[36:39], v[112:115], v[100:103], v[36:39]
    ds_read_b64 v[76:77], v12 offset:128
    v_mfma_f32_16x16x32_bf16 v[36:39], v[116:119], v[96:99], v[36:39]
    ds_read_b64 v[78:79], v12 offset:136
    v_mfma_f32_16x16x32_bf16 v[36:39], v[56:59], v[92:95], v[36:39]
    ds_read_b128 v[108:111], v7 offset:3712
    v_mfma_f32_16x16x32_bf16 v[36:39], v[60:63], v[88:91], v[36:39]
    ds_read_b64 v[48:49], v12 offset:3648
    v_mfma_f32_16x16x32_bf16 v[36:39], v[64:67], v[124:127], v[36:39]
    ds_read_b64 v[50:51], v12 offset:3656
    v_mfma_f32_16x16x32_bf16 v[36:39], v[68:71], v[120:123], v[36:39]
    ds_read_b128 v[80:83], v7 offset:64
    s_waitcnt lgkmcnt(6)
    v_mfma_f32_16x16x32_bf16 v[40:43], v[112:115], v[104:107], v[40:43]
    ds_read_b64 v[52:53], v12 offset:3136
    v_mfma_f32_16x16x32_bf16 v[40:43], v[116:119], v[100:103], v[40:43]
    ds_read_b64 v[54:55], v12 offset:3144
    v_mfma_f32_16x16x32_bf16 v[40:43], v[56:59], v[96:99], v[40:43]
    ds_read_b128 v[84:87], v7 offset:576
    v_mfma_f32_16x16x32_bf16 v[40:43], v[60:63], v[92:95], v[40:43]
    v_mfma_f32_16x16x32_bf16 v[40:43], v[64:67], v[88:91], v[40:43]
    v_mfma_f32_16x16x32_bf16 v[40:43], v[68:71], v[124:127], v[40:43]
    v_mfma_f32_16x16x32_bf16 v[40:43], v[72:75], v[120:123], v[40:43]
    s_waitcnt lgkmcnt(6)
    v_mfma_f32_16x16x32_bf16 v[44:47], v[112:115], v[108:111], v[44:47]
    v_mfma_f32_16x16x32_bf16 v[44:47], v[116:119], v[104:107], v[44:47]
    v_mfma_f32_16x16x32_bf16 v[44:47], v[56:59], v[100:103], v[44:47]
    v_mfma_f32_16x16x32_bf16 v[44:47], v[60:63], v[96:99], v[44:47]
    v_mfma_f32_16x16x32_bf16 v[44:47], v[64:67], v[92:95], v[44:47]
    v_mfma_f32_16x16x32_bf16 v[44:47], v[68:71], v[88:91], v[44:47]
    v_mfma_f32_16x16x32_bf16 v[44:47], v[72:75], v[124:127], v[44:47]
    v_mfma_f32_16x16x32_bf16 v[44:47], v[76:79], v[120:123], v[44:47]
    s_waitcnt lgkmcnt(3)
    v_mfma_f32_16x16x32_bf16 v[16:19], v[48:51], v[80:83], v[16:19]
    ds_read_b64 v[56:57], v12 offset:2624
    s_waitcnt lgkmcnt(1)
    v_mfma_f32_16x16x32_bf16 v[20:23], v[48:51], v[84:87], v[20:23]
    ds_read_b64 v[58:59], v12 offset:2632
    v_mfma_f32_16x16x32_bf16 v[20:23], v[52:55], v[80:83], v[20:23]
    ds_read_b128 v[88:91], v7 offset:1088
    s_waitcnt lgkmcnt(0)
    v_mfma_f32_16x16x32_bf16 v[24:27], v[48:51], v[88:91], v[24:27]
    ds_read_b64 v[60:61], v12 offset:2112
    v_mfma_f32_16x16x32_bf16 v[24:27], v[52:55], v[84:87], v[24:27]
    ds_read_b64 v[62:63], v12 offset:2120
    v_mfma_f32_16x16x32_bf16 v[24:27], v[56:59], v[80:83], v[24:27]
    ds_read_b128 v[92:95], v7 offset:1600
    s_waitcnt lgkmcnt(0)
    v_mfma_f32_16x16x32_bf16 v[28:31], v[48:51], v[92:95], v[28:31]
    ds_read_b64 v[64:65], v12 offset:1600
    v_mfma_f32_16x16x32_bf16 v[28:31], v[52:55], v[88:91], v[28:31]
    ds_read_b64 v[66:67], v12 offset:1608
    v_mfma_f32_16x16x32_bf16 v[28:31], v[56:59], v[84:87], v[28:31]
    ds_read_b128 v[96:99], v7 offset:2112
    v_mfma_f32_16x16x32_bf16 v[28:31], v[60:63], v[80:83], v[28:31]
    ds_read_b64 v[68:69], v12 offset:1088
    s_waitcnt lgkmcnt(1)
    v_mfma_f32_16x16x32_bf16 v[32:35], v[48:51], v[96:99], v[32:35]
    ds_read_b64 v[70:71], v12 offset:1096
    v_mfma_f32_16x16x32_bf16 v[32:35], v[52:55], v[92:95], v[32:35]
    ds_read_b128 v[100:103], v7 offset:2624
    v_mfma_f32_16x16x32_bf16 v[32:35], v[56:59], v[88:91], v[32:35]
    ds_read_b64 v[72:73], v12 offset:576
    v_mfma_f32_16x16x32_bf16 v[32:35], v[60:63], v[84:87], v[32:35]
    ds_read_b64 v[74:75], v12 offset:584
    v_mfma_f32_16x16x32_bf16 v[32:35], v[64:67], v[80:83], v[32:35]
    ds_read_b128 v[104:107], v7 offset:3136
    s_waitcnt lgkmcnt(3)
    v_mfma_f32_16x16x32_bf16 v[36:39], v[48:51], v[100:103], v[36:39]
    ds_read_b64 v[76:77], v12 offset:64
    v_mfma_f32_16x16x32_bf16 v[36:39], v[52:55], v[96:99], v[36:39]
    ds_read_b64 v[78:79], v12 offset:72
    v_mfma_f32_16x16x32_bf16 v[36:39], v[56:59], v[92:95], v[36:39]
    ds_read_b128 v[108:111], v7 offset:3648
    v_mfma_f32_16x16x32_bf16 v[36:39], v[60:63], v[88:91], v[36:39]
    ds_read_b64 v[112:113], v12 offset:3584
    v_mfma_f32_16x16x32_bf16 v[36:39], v[64:67], v[84:87], v[36:39]
    ds_read_b64 v[114:115], v12 offset:3592
    v_mfma_f32_16x16x32_bf16 v[36:39], v[68:71], v[80:83], v[36:39]
    ds_read_b128 v[120:123], v7 offset:0
    s_waitcnt lgkmcnt(6)
    v_mfma_f32_16x16x32_bf16 v[40:43], v[48:51], v[104:107], v[40:43]
    ds_read_b64 v[116:117], v12 offset:3072
    v_mfma_f32_16x16x32_bf16 v[40:43], v[52:55], v[100:103], v[40:43]
    ds_read_b64 v[118:119], v12 offset:3080
    v_mfma_f32_16x16x32_bf16 v[40:43], v[56:59], v[96:99], v[40:43]
    ds_read_b128 v[124:127], v7 offset:512
    v_mfma_f32_16x16x32_bf16 v[40:43], v[60:63], v[92:95], v[40:43]
    v_mfma_f32_16x16x32_bf16 v[40:43], v[64:67], v[88:91], v[40:43]
    v_mfma_f32_16x16x32_bf16 v[40:43], v[68:71], v[84:87], v[40:43]
    v_mfma_f32_16x16x32_bf16 v[40:43], v[72:75], v[80:83], v[40:43]
    s_waitcnt lgkmcnt(6)
    v_mfma_f32_16x16x32_bf16 v[44:47], v[48:51], v[108:111], v[44:47]
    v_mfma_f32_16x16x32_bf16 v[44:47], v[52:55], v[104:107], v[44:47]
    v_mfma_f32_16x16x32_bf16 v[44:47], v[56:59], v[100:103], v[44:47]
    v_mfma_f32_16x16x32_bf16 v[44:47], v[60:63], v[96:99], v[44:47]
    v_mfma_f32_16x16x32_bf16 v[44:47], v[64:67], v[92:95], v[44:47]
    v_mfma_f32_16x16x32_bf16 v[44:47], v[68:71], v[88:91], v[44:47]
    v_mfma_f32_16x16x32_bf16 v[44:47], v[72:75], v[84:87], v[44:47]
    v_mfma_f32_16x16x32_bf16 v[44:47], v[76:79], v[80:83], v[44:47]
    s_waitcnt lgkmcnt(3)
    v_mfma_f32_16x16x32_bf16 v[16:19], v[112:115], v[120:123], v[16:19]
    ds_read_b64 v[56:57], v12 offset:2560
    s_waitcnt lgkmcnt(1)
    v_mfma_f32_16x16x32_bf16 v[20:23], v[112:115], v[124:127], v[20:23]
    ds_read_b64 v[58:59], v12 offset:2568
    v_mfma_f32_16x16x32_bf16 v[20:23], v[116:119], v[120:123], v[20:23]
    ds_read_b128 v[88:91], v7 offset:1024
    s_waitcnt lgkmcnt(0)
    v_mfma_f32_16x16x32_bf16 v[24:27], v[112:115], v[88:91], v[24:27]
    ds_read_b64 v[60:61], v12 offset:2048
    v_mfma_f32_16x16x32_bf16 v[24:27], v[116:119], v[124:127], v[24:27]
    ds_read_b64 v[62:63], v12 offset:2056
    v_mfma_f32_16x16x32_bf16 v[24:27], v[56:59], v[120:123], v[24:27]
    ds_read_b128 v[92:95], v7 offset:1536
    s_waitcnt lgkmcnt(0)
    v_mfma_f32_16x16x32_bf16 v[28:31], v[112:115], v[92:95], v[28:31]
    ds_read_b64 v[64:65], v12 offset:1536
    v_mfma_f32_16x16x32_bf16 v[28:31], v[116:119], v[88:91], v[28:31]
    ds_read_b64 v[66:67], v12 offset:1544
    v_mfma_f32_16x16x32_bf16 v[28:31], v[56:59], v[124:127], v[28:31]
    ds_read_b128 v[96:99], v7 offset:2048
    v_mfma_f32_16x16x32_bf16 v[28:31], v[60:63], v[120:123], v[28:31]
    ds_read_b64 v[68:69], v12 offset:1024
    s_waitcnt lgkmcnt(1)
    v_mfma_f32_16x16x32_bf16 v[32:35], v[112:115], v[96:99], v[32:35]
    ds_read_b64 v[70:71], v12 offset:1032
    v_mfma_f32_16x16x32_bf16 v[32:35], v[116:119], v[92:95], v[32:35]
    ds_read_b128 v[100:103], v7 offset:2560
    v_mfma_f32_16x16x32_bf16 v[32:35], v[56:59], v[88:91], v[32:35]
    ds_read_b64 v[72:73], v12 offset:512
    v_mfma_f32_16x16x32_bf16 v[32:35], v[60:63], v[124:127], v[32:35]
    ds_read_b64 v[74:75], v12 offset:520
    v_mfma_f32_16x16x32_bf16 v[32:35], v[64:67], v[120:123], v[32:35]
    ds_read_b128 v[104:107], v7 offset:3072
    s_waitcnt lgkmcnt(3)
    v_mfma_f32_16x16x32_bf16 v[36:39], v[112:115], v[100:103], v[36:39]
    ds_read_b64 v[76:77], v12 offset:0
    v_mfma_f32_16x16x32_bf16 v[36:39], v[116:119], v[96:99], v[36:39]
    ds_read_b64 v[78:79], v12 offset:8
    v_mfma_f32_16x16x32_bf16 v[36:39], v[56:59], v[92:95], v[36:39]
    ds_read_b128 v[108:111], v7 offset:3584
    v_mfma_f32_16x16x32_bf16 v[36:39], v[60:63], v[88:91], v[36:39]
    v_mfma_f32_16x16x32_bf16 v[36:39], v[64:67], v[124:127], v[36:39]
    v_mfma_f32_16x16x32_bf16 v[36:39], v[68:71], v[120:123], v[36:39]
    s_waitcnt lgkmcnt(3)
    v_mfma_f32_16x16x32_bf16 v[40:43], v[112:115], v[104:107], v[40:43]
    v_mfma_f32_16x16x32_bf16 v[40:43], v[116:119], v[100:103], v[40:43]
    v_mfma_f32_16x16x32_bf16 v[40:43], v[56:59], v[96:99], v[40:43]
    v_mfma_f32_16x16x32_bf16 v[40:43], v[60:63], v[92:95], v[40:43]
    v_mfma_f32_16x16x32_bf16 v[40:43], v[64:67], v[88:91], v[40:43]
    v_mfma_f32_16x16x32_bf16 v[40:43], v[68:71], v[124:127], v[40:43]
    v_mfma_f32_16x16x32_bf16 v[40:43], v[72:75], v[120:123], v[40:43]
    s_waitcnt lgkmcnt(0)
    v_mfma_f32_16x16x32_bf16 v[44:47], v[112:115], v[108:111], v[44:47]
    v_mfma_f32_16x16x32_bf16 v[44:47], v[116:119], v[104:107], v[44:47]
    v_mfma_f32_16x16x32_bf16 v[44:47], v[56:59], v[100:103], v[44:47]
    v_mfma_f32_16x16x32_bf16 v[44:47], v[60:63], v[96:99], v[44:47]
    v_mfma_f32_16x16x32_bf16 v[44:47], v[64:67], v[92:95], v[44:47]
    v_mfma_f32_16x16x32_bf16 v[44:47], v[68:71], v[88:91], v[44:47]
    v_mfma_f32_16x16x32_bf16 v[44:47], v[72:75], v[124:127], v[44:47]
    v_mfma_f32_16x16x32_bf16 v[44:47], v[76:79], v[120:123], v[44:47]
    s_lshl_b32 s49, s37, 12
    s_add_u32 s49, s49, s39
    s_add_u32 s49, s49, 4160
    v_add_u32 v5, s49, v4
    s_xor_b32 s49, s37, 1
    s_lshl_b32 s49, s49, 12
    s_add_u32 s49, s49, s39
    s_add_u32 s49, s49, 4160
    v_add_u32 v6, s49, v4
    s_barrier
    s_cmp_eq_u32 s37, 0
    s_cbranch_scc1 cv_h0

    ds_write_b128 v5, v[16:19] offset:0
    ds_write_b128 v5, v[20:23] offset:1024
    ds_write_b128 v5, v[24:27] offset:2048
    ds_write_b128 v5, v[28:31] offset:3072
    v_mov_b32 v64, v32
    v_mov_b32 v65, v33
    v_mov_b32 v66, v34
    v_mov_b32 v67, v35
    v_mov_b32 v68, v36
    v_mov_b32 v69, v37
    v_mov_b32 v70, v38
    v_mov_b32 v71, v39
    v_mov_b32 v72, v40
    v_mov_b32 v73, v41
    v_mov_b32 v74, v42
    v_mov_b32 v75, v43
    v_mov_b32 v76, v44
    v_mov_b32 v77, v45
    v_mov_b32 v78, v46
    v_mov_b32 v79, v47
    s_branch cv_hj
cv_h0:
    ds_write_b128 v5, v[32:35] offset:0
    ds_write_b128 v5, v[36:39] offset:1024
    ds_write_b128 v5, v[40:43] offset:2048
    ds_write_b128 v5, v[44:47] offset:3072
    v_mov_b32 v64, v16
    v_mov_b32 v65, v17
    v_mov_b32 v66, v18
    v_mov_b32 v67, v19
    v_mov_b32 v68, v20
    v_mov_b32 v69, v21
    v_mov_b32 v70, v22
    v_mov_b32 v71, v23
    v_mov_b32 v72, v24
    v_mov_b32 v73, v25
    v_mov_b32 v74, v26
    v_mov_b32 v75, v27
    v_mov_b32 v76, v28
    v_mov_b32 v77, v29
    v_mov_b32 v78, v30
    v_mov_b32 v79, v31
cv_hj:
    v_lshlrev_b32 v8, 5, v2
    v_lshl_add_u32 v8, v3, 3, v8
    v_sub_u32 v9, 504, v8
    s_xor_b32 s49, s37, 1
    s_lshl_b32 s49, s49, 11
    s_add_u32 s49, s49, s39
    v_add_u32 v9, s49, v9
    s_mul_i32 s49, s37, 2176
    s_add_u32 s49, s49, s39
    v_add_u32 v8, s49, v8
    s_bitcmp1_b32 s48, 0
    s_cselect_b32 s49, 0, 16
    s_lshl_b32 s54, s54, s49
    s_and_b32 s54, s54, 0xffff0000

    ds_read_b64 v[48:49], v9 offset:1536
    ds_read_b64 v[50:51], v9 offset:1024
    ds_read_b64 v[52:53], v9 offset:512
    ds_read_b64 v[54:55], v9 offset:0
    s_waitcnt lgkmcnt(0)
    s_barrier
    ds_read_b128 v[80:83], v6 offset:0
    ds_read_b128 v[84:87], v6 offset:1024
    ds_read_b128 v[88:91], v6 offset:2048
    ds_read_b128 v[92:95], v6 offset:3072
    v_and_b32 v96, 0xffff0000, v49
    v_lshlrev_b32 v97, 16, v49
    v_and_b32 v98, 0xffff0000, v48
    v_lshlrev_b32 v99, 16, v48
    v_fma_f32 v96, v96, s54, v64
    v_fma_f32 v97, v97, s54, v65
    v_fma_f32 v98, v98, s54, v66
    v_fma_f32 v99, v99, s54, v67
    v_and_b32 v100, 0xffff0000, v51
    v_lshlrev_b32 v101, 16, v51
    v_and_b32 v102, 0xffff0000, v50
    v_lshlrev_b32 v103, 16, v50
    v_fma_f32 v100, v100, s54, v68
    v_fma_f32 v101, v101, s54, v69
    v_fma_f32 v102, v102, s54, v70
    v_fma_f32 v103, v103, s54, v71
    v_and_b32 v104, 0xffff0000, v53
    v_lshlrev_b32 v105, 16, v53
    v_and_b32 v106, 0xffff0000, v52
    v_lshlrev_b32 v107, 16, v52
    v_fma_f32 v104, v104, s54, v72
    v_fma_f32 v105, v105, s54, v73
    v_fma_f32 v106, v106, s54, v74
    v_fma_f32 v107, v107, s54, v75
    v_and_b32 v108, 0xffff0000, v55
    v_lshlrev_b32 v109, 16, v55
    v_and_b32 v110, 0xffff0000, v54
    v_lshlrev_b32 v111, 16, v54
    v_fma_f32 v108, v108, s54, v76
    v_fma_f32 v109, v109, s54, v77
    v_fma_f32 v110, v110, s54, v78
    v_fma_f32 v111, v111, s54, v79
    s_waitcnt lgkmcnt(0)
    v_add_f32 v96, v96, v80
    v_add_f32 v97, v97, v81
    v_add_f32 v98, v98, v82
    v_add_f32 v99, v99, v83
    v_cvt_pk_bf16_f32 v96, v96, v97
    v_cvt_pk_bf16_f32 v97, v98, v99
    ds_write_b64 v8, v[96:97] offset:16640
    v_add_f32 v100, v100, v84
    v_add_f32 v101, v101, v85
    v_add_f32 v102, v102, v86
    v_add_f32 v103, v103, v87
    v_cvt_pk_bf16_f32 v100, v100, v101
    v_cvt_pk_bf16_f32 v101, v102, v103
    ds_write_b64 v8, v[100:101] offset:17152
    v_add_f32 v104, v104, v88
    v_add_f32 v105, v105, v89
    v_add_f32 v106, v106, v90
    v_add_f32 v107, v107, v91
    v_cvt_pk_bf16_f32 v104, v104, v105
    v_cvt_pk_bf16_f32 v105, v106, v107
    ds_write_b64 v8, v[104:105] offset:17664
    v_add_f32 v108, v108, v92
    v_add_f32 v109, v109, v93
    v_add_f32 v110, v110, v94
    v_add_f32 v111, v111, v95
    v_cvt_pk_bf16_f32 v108, v108, v109
    v_cvt_pk_bf16_f32 v109, v110, v111
    ds_write_b64 v8, v[108:109] offset:18176
    v_bfe_u32 v5, v0, 2, 1
    v_mul_u32_u24 v5, 21312, v5
    v_bfe_u32 v6, v0, 3, 1
    v_mul_u32_u24 v6, 2176, v6
    v_add_u32 v5, v5, v6
    v_lshl_add_u32 v5, v3, 5, v5
    v_and_b32 v6, 3, v0
    v_lshl_add_u32 v5, v6, 3, v5
    s_lshr_b32 s49, s38, 2
    s_mul_i32 s50, s49, 42624
    s_and_b32 s51, s38, 3
    s_lshl_b32 s52, s51, 9
    s_add_u32 s50, s50, s52
    v_add_u32 v5, s50, v5
    v_lshlrev_b32 v6, 2, v0
    s_mul_i32 s50, s3, 3
    s_add_u32 s50, s50, s49
    s_lshl_b32 s50, s50, 13
    s_lshl_b32 s51, s51, 10
    s_add_u32 s50, s50, s51
    s_add_u32 s51, s50, 4096
    s_waitcnt lgkmcnt(0)
    s_barrier

    ds_read_b64_tr_b16 v[16:17], v5 offset:16640
    ds_read_b64_tr_b16 v[18:19], v5 offset:16768
    ds_read_b64_tr_b16 v[20:21], v5 offset:16896
    ds_read_b64_tr_b16 v[22:23], v5 offset:17024
    s_waitcnt lgkmcnt(0)
    s_barrier
    buffer_store_dword v16, v6, s[44:47], s50 offen offset:0 sc1
    buffer_store_dword v17, v6, s[44:47], s51 offen offset:0 sc1
    buffer_store_dword v18, v6, s[44:47], s50 offen offset:256 sc1
    buffer_store_dword v19, v6, s[44:47], s51 offen offset:256 sc1
    buffer_store_dword v20, v6, s[44:47], s50 offen offset:512 sc1
    buffer_store_dword v21, v6, s[44:47], s51 offen offset:512 sc1
    buffer_store_dword v22, v6, s[44:47], s50 offen offset:768 sc1
    buffer_store_dword v23, v6, s[44:47], s51 offen offset:768 sc1
    s_lshl_b32 s52, s3, 2
    s_waitcnt vmcnt(0)
    v_mov_b32 v10, 163004
    v_mov_b32 v11, 1
    s_mov_b64 exec, 1
    ds_add_rtn_u32 v10, v10, v11
    s_waitcnt lgkmcnt(0)
    v_cmp_ne_u32 vcc, 11, v10
    s_cbranch_vccnz z_pub
    v_mov_b32 v10, s52
    s_nop 0
    v_add_u32 v10, 12544, v10
    buffer_store_dword v11, v10, s[40:43], 0 offen sc1
    z_pub:
    s_mov_b64 exec, -1

    s_branch k3_entry
k3_entry:
    s_waitcnt lgkmcnt(0)
    v_mbcnt_lo_u32_b32 v0, -1, 0
    v_mbcnt_hi_u32_b32 v0, -1, v0
    s_lshl_b32 s14, s101, 6
    v_add_u32 v0, s14, v0
    s_load_dwordx2 s[4:5], s[0:1], 72
    s_load_dwordx2 s[6:7], s[0:1], 80
    s_load_dwordx2 s[8:9], s[0:1], 0
    s_load_dwordx2 s[10:11], s[0:1], 112
    s_load_dwordx2 s[12:13], s[0:1], 96
    s_and_b32 s14, s2, 3
    s_lshl_b32 s14, s14, 1
    s_bfe_u32 s15, s2, 0x10003
    s_add_u32 s56, s14, s15
    s_bfe_u32 s14, s2, 0x10002
    s_lshl_b32 s14, s14, 4
    s_lshr_b32 s15, s2, 4
    s_add_u32 s57, s14, s15

    v_lshrrev_b32 v1, 6, v0
    v_and_b32 v0, 63, v0
    v_readfirstlane_b32 s14, v1
    s_mov_b32 s3, 0x4000
    s_lshr_b32 s15, s14, 2
    s_lshl_b32 s15, s15, 1
    s_lshr_b32 s58, 75, s15
    s_and_b32 s58, s58, 3
    s_and_b32 s59, s14, 3
    v_and_b32 v9, 15, v0
    v_lshrrev_b32 v10, 4, v0
    v_lshlrev_b32 v7, 4, v0
    v_mov_b32 v2, 0
    v_mov_b32 v3, 0
    v_mov_b32 v11, 0
    v_mov_b32 v12, 0
    v_mov_b32 v13, 0
    s_cmp_lg_u32 s58, 3
    s_cbranch_scc1 k3_comp

k3_loader:
    v_add_u32 v12, 0, v0
    v_mul_u32_u24 v13, 2731, v12
    v_lshrrev_b32 v13, 16, v13
    v_mul_u32_u24 v14, 24, v13
    v_sub_u32 v14, v12, v14
    v_and_b32 v11, 6, v13
    v_xor_b32 v14, v14, v11
    v_lshlrev_b32 v14, 4, v14
    v_subrev_u32 v14, 0, v14
    v_mul_u32_u24 v11, 9216, v13
    v_add_u32 v16, v14, v11
    v_mul_u32_u24 v11, 1152, v13
    v_add_u32 v20, v14, v11

    v_add_u32 v12, 64, v0
    v_mul_u32_u24 v13, 2731, v12
    v_lshrrev_b32 v13, 16, v13
    v_mul_u32_u24 v14, 24, v13
    v_sub_u32 v14, v12, v14
    v_and_b32 v11, 6, v13
    v_xor_b32 v14, v14, v11
    v_lshlrev_b32 v14, 4, v14
    v_subrev_u32 v14, 1024, v14
    v_mul_u32_u24 v11, 9216, v13
    v_add_u32 v17, v14, v11
    v_mul_u32_u24 v11, 1152, v13
    v_add_u32 v21, v14, v11

    v_add_u32 v12, 128, v0
    v_mul_u32_u24 v13, 2731, v12
    v_lshrrev_b32 v13, 16, v13
    v_mul_u32_u24 v14, 24, v13
    v_sub_u32 v14, v12, v14
    v_and_b32 v11, 6, v13
    v_xor_b32 v14, v14, v11
    v_lshlrev_b32 v14, 4, v14
    v_subrev_u32 v14, 2048, v14
    v_mul_u32_u24 v11, 9216, v13
    v_add_u32 v18, v14, v11
    v_mul_u32_u24 v11, 1152, v13
    v_add_u32 v22, v14, v11

    s_waitcnt lgkmcnt(0)
    s_mov_b32 s16, s4
    s_and_b32 s17, s5, 0xffff
    s_mov_b32 s18, 5308416
    s_mov_b32 s19, 0x20000
    s_add_u32 s24, s10, 2359296
    s_addc_u32 s25, s11, 0
    s_and_b32 s25, s25, 0xffff
    s_mov_b32 s26, 2359296
    s_mov_b32 s27, 0x20000
    s_mov_b32 s20, s6
    s_and_b32 s21, s7, 0xffff
    s_mov_b32 s22, 5308416
    s_mov_b32 s23, 0x20000
    s_add_u32 s48, s10, 12124160
    s_addc_u32 s49, s11, 0
    s_and_b32 s49, s49, 0xffff
    s_mov_b32 s50, 18432
    s_mov_b32 s51, 0x20000
    s_mul_i32 s14, s56, 663552
    s_mul_i32 s15, s57, 20736
    s_add_u32 s14, s14, s15
    s_lshl_b32 s15, s59, 6
    s_add_u32 s14, s14, s15
    s_add_u32 s28, s6, s14
    s_addc_u32 s29, s7, 0

    s_mul_i32 s4, s56, 1152
    s_mul_i32 s6, s59, 73728
    s_add_u32 s4, s4, s6
    s_mul_i32 s5, s56, 663552
    s_mul_i32 s6, s59, 9216
    s_add_u32 s5, s5, s6
    s_mul_i32 s6, s59, 3072
    s_add_u32 s6, s6, 73728
    s_lshl_b32 s14, s57, 2
    s_add_u32 s14, s14, s59
    s_mul_i32 s62, s14, 18432
    s_lshl_b32 s63, s59, 10
    s_lshr_b32 s14, s59, 1
    s_mul_i32 s14, s14, 55296
    s_add_u32 s60, s5, s14
    s_setprio 1

    s_add_u32 m0, s6, 0
    s_add_u32 s7, s4, 0
    buffer_load_dwordx4 v16, s[16:19], s7 offen offset:0  lds
    buffer_load_dwordx4 v17, s[16:19], s7 offen offset:1024  lds
    buffer_load_dwordx4 v18, s[16:19], s7 offen offset:2048  lds
    s_add_u32 m0, s6, 12288
    s_add_u32 s7, s4, 294912
    buffer_load_dwordx4 v16, s[16:19], s7 offen offset:0  lds
    buffer_load_dwordx4 v17, s[16:19], s7 offen offset:1024  lds
    buffer_load_dwordx4 v18, s[16:19], s7 offen offset:2048  lds
    s_add_u32 m0, s6, 24576
    s_add_u32 s7, s4, 589824
    buffer_load_dwordx4 v16, s[16:19], s7 offen offset:0  lds
    buffer_load_dwordx4 v17, s[16:19], s7 offen offset:1024  lds
    buffer_load_dwordx4 v18, s[16:19], s7 offen offset:2048  lds
    s_add_u32 m0, s6, 36864
    s_add_u32 s7, s4, 884736
    buffer_load_dwordx4 v16, s[16:19], s7 offen offset:0  lds
    buffer_load_dwordx4 v17, s[16:19], s7 offen offset:1024  lds
    buffer_load_dwordx4 v18, s[16:19], s7 offen offset:2048  lds
    s_add_u32 m0, s6, 49152
    s_add_u32 s7, s4, 1179648
    buffer_load_dwordx4 v16, s[16:19], s7 offen offset:0  lds
    buffer_load_dwordx4 v17, s[16:19], s7 offen offset:1024  lds
    buffer_load_dwordx4 v18, s[16:19], s7 offen offset:2048  lds
    s_add_u32 m0, s6, 61440
    s_add_u32 s7, s4, 1474560
    buffer_load_dwordx4 v16, s[16:19], s7 offen offset:0  lds
    buffer_load_dwordx4 v17, s[16:19], s7 offen offset:1024  lds
    buffer_load_dwordx4 v18, s[16:19], s7 offen offset:2048  lds
    s_add_u32 s32, s10, 0
    s_addc_u32 s33, s11, 0
    s_and_b32 s33, s33, 0xffff
    s_mov_b32 s34, 35651584
    s_mov_b32 s35, 0x20000
    s_mov_b32 s40, s8
    s_and_b32 s41, s9, 0xffff
    s_mov_b32 s42, 2359296
    s_mov_b32 s43, 0x20000
    s_mov_b32 s52, s12
    s_and_b32 s53, s13, 0xffff
    s_mov_b32 s54, 2359296
    s_mov_b32 s55, 0x20000
    s_cmp_eq_u32 s59, 3
    s_cselect_b32 s34, 0, s34
    s_cselect_b32 s42, 0, s42
    s_cselect_b32 s54, 0, s54
    s_cselect_b32 s12, 0, 1
    s_mul_i32 s61, s56, 3
    s_add_u32 s61, s61, s59
    s_min_u32 s61, s61, 23
    s_lshr_b32 s30, s61, 3
    s_lshl_b32 s30, s30, 2
    s_and_b32 s31, s61, 3
    s_add_u32 s30, s30, s31
    s_lshl_b32 s8, s30, 5
    s_lshl_b32 s9, s30, 16
    s_add_u32 s9, s9, 9437184
    s_mul_i32 s14, s57, 12
    s_add_u32 s10, s14, s31
    s_lshl_b32 s10, s10, 5
    s_add_u32 s10, s10, 33554432
    s_mul_i32 s11, s57, 72
    s_add_u32 s11, s11, s61
    s_lshl_b32 s11, s11, 13
    s_add_u32 s11, s11, 12582912
    s_bfe_u32 s14, s61, 0x10002
    s_lshl_b32 s15, s57, 6
    s_lshl_b32 s31, s14, 5
    s_add_u32 s15, s15, s31
    v_and_b32 v1, 31, v0
    v_add_u32 v1, s15, v1
    v_lshrrev_b32 v5, 5, v0
    v_lshlrev_b32 v2, 2, v1
    v_mul_u32_u24 v3, 1152, v1
    v_lshl_add_u32 v3, v5, 4, v3
    v_lshl_add_u32 v4, v5, 15, v2
    v_add_u32 v12, 8192, v4
    v_add_u32 v8, 16384, v4
    v_add_u32 v6, 24576, v4
    v_add_u32 v2, 12058624, v2
    s_lshr_b32 s15, s30, 1
    s_lshl_b32 s15, s15, 12
    s_lshl_b32 s14, s14, 11
    s_add_u32 s15, s15, s14
    s_and_b32 s14, s30, 1
    s_lshl_b32 s14, s14, 3
    s_add_u32 s15, s15, s14
    v_and_b32 v11, 1, v10
    v_lshlrev_b32 v11, 10, v11
    v_lshl_add_u32 v11, v5, 9, v11
    v_lshl_add_u32 v11, v9, 4, v11
    v_add_u32 v11, s15, v11
    v_and_b32 v5, 7, v0
    v_lshlrev_b32 v5, 2, v5
    v_min_u32 v13, 11, v0
    v_lshrrev_b32 v14, 2, v13
    v_mul_u32_u24 v14, 192, v14
    v_and_b32 v13, 3, v13
    v_mul_u32_u24 v13, 6, v13
    v_min_u32 v13, 15, v13
    s_lshl_b32 s14, s30, 4
    v_add3_u32 v13, v13, v14, s14
    v_mul_u32_u24 v13, 10923, v13
    v_lshrrev_b32 v13, 16, v13
    v_lshlrev_b32 v13, 2, v13
    v_add_u32 v13, 12202240, v13

    buffer_load_dwordx4 v[24:27], v3, s[40:43], s8 offen offset:0
    buffer_load_dwordx4 v[28:31], v3, s[40:43], s8 offen offset:384
    buffer_load_dwordx4 v[32:35], v3, s[40:43], s8 offen offset:768
    s_barrier
    s_add_u32 m0, s63, 0
    s_add_u32 s7, s62, 0
    buffer_load_dwordx4 v7, s[24:27], s7 offen sc1 lds
    s_add_u32 m0, s63, 4096
    s_add_u32 s7, s62, 1024
    buffer_load_dwordx4 v7, s[24:27], s7 offen sc1 lds
    s_add_u32 m0, s63, 8192
    s_add_u32 s7, s62, 2048
    buffer_load_dwordx4 v7, s[24:27], s7 offen sc1 lds
    s_add_u32 m0, s63, 12288
    s_add_u32 s7, s62, 3072
    buffer_load_dwordx4 v7, s[24:27], s7 offen sc1 lds
    s_add_u32 m0, s63, 16384
    s_add_u32 s7, s62, 4096
    buffer_load_dwordx4 v7, s[24:27], s7 offen sc1 lds
    s_add_u32 m0, s63, 20480
    s_add_u32 s7, s62, 5120
    buffer_load_dwordx4 v7, s[24:27], s7 offen sc1 lds
    s_waitcnt vmcnt(5)
    s_barrier
    s_waitcnt vmcnt(4)
    s_barrier
    s_add_u32 m0, s63, 24576
    s_add_u32 s7, s62, 6144
    buffer_load_dwordx4 v7, s[24:27], s7 offen sc1 lds
    s_add_u32 m0, s6, 73728
    s_add_u32 s7, s4, 1769472
    buffer_load_dwordx4 v16, s[16:19], s7 offen offset:0  lds
    s_load_dword s2, s[28:29], 0
    buffer_load_dwordx4 v17, s[16:19], s7 offen offset:1024  lds
    buffer_load_dwordx4 v18, s[16:19], s7 offen offset:2048  lds
    s_waitcnt vmcnt(7)
    s_barrier
    s_add_u32 m0, s63, 28672
    s_add_u32 s7, s62, 7168
    buffer_load_dwordx4 v7, s[24:27], s7 offen sc1 lds
    s_add_u32 m0, s6, 0
    s_add_u32 s7, s4, 2064384
    buffer_load_dwordx4 v16, s[16:19], s7 offen offset:0  lds
    s_load_dword s2, s[28:29], 256
    buffer_load_dwordx4 v17, s[16:19], s7 offen offset:1024  lds
    buffer_load_dwordx4 v18, s[16:19], s7 offen offset:2048  lds
    s_waitcnt vmcnt(10)
    s_barrier
    s_add_u32 m0, s63, 32768
    s_add_u32 s7, s62, 8192
    buffer_load_dwordx4 v7, s[24:27], s7 offen sc1 lds
    s_add_u32 m0, s6, 12288
    s_add_u32 s7, s4, 2359296
    buffer_load_dwordx4 v16, s[16:19], s7 offen offset:0  lds
    s_load_dword s2, s[28:29], 1024
    buffer_load_dwordx4 v17, s[16:19], s7 offen offset:1024  lds
    buffer_load_dwordx4 v18, s[16:19], s7 offen offset:2048  lds
    s_min_u32 s14, s59, 2
    s_lshl_b32 s14, s14, 10
    s_add_u32 m0, s14, 159744
    s_mul_i32 s15, s56, 2304
    s_add_u32 s15, s15, s14
    buffer_load_dwordx4 v7, s[48:51], s15 offen sc1 lds
    s_waitcnt vmcnt(14)
    s_barrier
    s_add_u32 m0, s63, 36864
    s_add_u32 s7, s62, 9216
    buffer_load_dwordx4 v7, s[24:27], s7 offen sc1 lds
    s_add_u32 m0, s6, 24576
    s_add_u32 s7, s4, 2654208
    buffer_load_dwordx4 v16, s[16:19], s7 offen offset:0  lds
    s_load_dword s2, s[28:29], 1280
    buffer_load_dwordx4 v17, s[16:19], s7 offen offset:1024  lds
    buffer_load_dwordx4 v18, s[16:19], s7 offen offset:2048  lds
    s_waitcnt vmcnt(17)
    s_barrier
    s_add_u32 m0, s63, 40960
    s_add_u32 s7, s62, 10240
    buffer_load_dwordx4 v7, s[24:27], s7 offen sc1 lds
    s_add_u32 m0, s6, 36864
    s_add_u32 s7, s4, 2949120
    buffer_load_dwordx4 v16, s[16:19], s7 offen offset:0  lds
    s_load_dword s2, s[28:29], 2304
    buffer_load_dwordx4 v17, s[16:19], s7 offen offset:1024  lds
    buffer_load_dwordx4 v18, s[16:19], s7 offen offset:2048  lds
    s_waitcnt vmcnt(17)
    s_barrier
    s_add_u32 m0, s63, 45056
    s_add_u32 s7, s62, 11264
    buffer_load_dwordx4 v7, s[24:27], s7 offen sc1 lds
    s_add_u32 m0, s6, 49152
    s_add_u32 s7, s4, 3244032
    buffer_load_dwordx4 v16, s[16:19], s7 offen offset:0  lds
    s_load_dword s2, s[28:29], 2560
    buffer_load_dwordx4 v17, s[16:19], s7 offen offset:1024  lds
    buffer_load_dwordx4 v18, s[16:19], s7 offen offset:2048  lds
    s_waitcnt vmcnt(17)
    s_barrier
    s_add_u32 m0, s63, 49152
    s_add_u32 s7, s62, 12288
    buffer_load_dwordx4 v7, s[24:27], s7 offen sc1 lds
    s_add_u32 m0, s6, 61440
    s_add_u32 s7, s4, 3538944
    buffer_load_dwordx4 v16, s[16:19], s7 offen offset:0  lds
    s_load_dword s2, s[28:29], 3328
    buffer_load_dwordx4 v17, s[16:19], s7 offen offset:1024  lds
    buffer_load_dwordx4 v18, s[16:19], s7 offen offset:2048  lds
    s_waitcnt vmcnt(16)
    s_barrier
    s_add_u32 m0, s63, 53248
    s_add_u32 s7, s62, 13312
    buffer_load_dwordx4 v7, s[24:27], s7 offen sc1 lds
    s_add_u32 m0, s6, 73728
    s_add_u32 s7, s4, 3833856
    buffer_load_dwordx4 v16, s[16:19], s7 offen offset:0  lds
    s_load_dword s2, s[28:29], 3584
    buffer_load_dwordx4 v17, s[16:19], s7 offen offset:1024  lds
    buffer_load_dwordx4 v18, s[16:19], s7 offen offset:2048  lds
    s_waitcnt vmcnt(16)
    s_barrier
    s_add_u32 m0, s63, 57344
    s_add_u32 s7, s62, 14336
    buffer_load_dwordx4 v7, s[24:27], s7 offen sc1 lds
    s_add_u32 m0, s6, 0
    s_add_u32 s7, s4, 4128768
    buffer_load_dwordx4 v16, s[16:19], s7 offen offset:0  lds
    s_load_dword s2, s[28:29], 4608
    buffer_load_dwordx4 v17, s[16:19], s7 offen offset:1024  lds
    buffer_load_dwordx4 v18, s[16:19], s7 offen offset:2048  lds
    s_waitcnt vmcnt(16)
    s_barrier
    s_add_u32 m0, s63, 61440
    s_add_u32 s7, s62, 15360
    buffer_load_dwordx4 v7, s[24:27], s7 offen sc1 lds
    s_add_u32 m0, s6, 12288
    s_add_u32 s7, s4, 4423680
    buffer_load_dwordx4 v16, s[16:19], s7 offen offset:0  lds
    s_load_dword s2, s[28:29], 4864
    buffer_load_dwordx4 v17, s[16:19], s7 offen offset:1024  lds
    buffer_load_dwordx4 v18, s[16:19], s7 offen offset:2048  lds
    s_waitcnt vmcnt(16)
    s_barrier
    s_add_u32 m0, s63, 65536
    s_add_u32 s7, s62, 16384
    buffer_load_dwordx4 v7, s[24:27], s7 offen sc1 lds
    s_add_u32 m0, s6, 24576
    s_add_u32 s7, s4, 4718592
    buffer_load_dwordx4 v16, s[16:19], s7 offen offset:0  lds
    s_load_dword s2, s[28:29], 5632
    buffer_load_dwordx4 v17, s[16:19], s7 offen offset:1024  lds
    buffer_load_dwordx4 v18, s[16:19], s7 offen offset:2048  lds
    s_waitcnt vmcnt(16)
    s_barrier
    s_add_u32 m0, s63, 69632
    s_add_u32 s7, s62, 17408
    buffer_load_dwordx4 v7, s[24:27], s7 offen sc1 lds
    s_add_u32 m0, s6, 36864
    s_add_u32 s7, s4, 5013504
    buffer_load_dwordx4 v16, s[16:19], s7 offen offset:0  lds
    s_load_dword s2, s[28:29], 5888
    buffer_load_dwordx4 v17, s[16:19], s7 offen offset:1024  lds
    buffer_load_dwordx4 v18, s[16:19], s7 offen offset:2048  lds
    s_waitcnt vmcnt(16)
    s_barrier
    s_add_u32 m0, s6, 49152
    s_add_u32 s7, s4, 384
    buffer_load_dwordx4 v16, s[16:19], s7 offen offset:0  lds
    s_load_dword s2, s[28:29], 6912
    buffer_load_dwordx4 v17, s[16:19], s7 offen offset:1024  lds
    buffer_load_dwordx4 v18, s[16:19], s7 offen offset:2048  lds
    s_waitcnt vmcnt(15)
    s_barrier
    s_add_u32 m0, s6, 61440
    s_add_u32 s7, s4, 295296
    buffer_load_dwordx4 v16, s[16:19], s7 offen offset:0  lds
    s_load_dword s2, s[28:29], 7168
    buffer_load_dwordx4 v17, s[16:19], s7 offen offset:1024  lds
    buffer_load_dwordx4 v18, s[16:19], s7 offen offset:2048  lds
    s_waitcnt vmcnt(14)
    s_barrier
    s_add_u32 m0, s6, 73728
    s_add_u32 s7, s4, 590208
    buffer_load_dwordx4 v16, s[16:19], s7 offen offset:0  lds
    s_load_dword s2, s[28:29], 7936
    buffer_load_dwordx4 v17, s[16:19], s7 offen offset:1024  lds
    buffer_load_dwordx4 v18, s[16:19], s7 offen offset:2048  lds
    s_waitcnt vmcnt(13)
    s_barrier
    s_add_u32 m0, s6, 0
    s_add_u32 s7, s4, 885120
    buffer_load_dwordx4 v16, s[16:19], s7 offen offset:0  lds
    s_load_dword s2, s[28:29], 8192
    buffer_load_dwordx4 v17, s[16:19], s7 offen offset:1024  lds
    buffer_load_dwordx4 v18, s[16:19], s7 offen offset:2048  lds
    s_waitcnt vmcnt(12)
    s_barrier
    s_add_u32 m0, s6, 12288
    s_add_u32 s7, s4, 1180032
    buffer_load_dwordx4 v16, s[16:19], s7 offen offset:0  lds
    s_load_dword s2, s[28:29], 9216
    buffer_load_dwordx4 v17, s[16:19], s7 offen offset:1024  lds
    buffer_load_dwordx4 v18, s[16:19], s7 offen offset:2048  lds
    s_waitcnt vmcnt(12)
    s_barrier
    s_add_u32 m0, s6, 24576
    s_add_u32 s7, s4, 1474944
    buffer_load_dwordx4 v16, s[16:19], s7 offen offset:0  lds
    s_load_dword s2, s[28:29], 9472
    buffer_load_dwordx4 v17, s[16:19], s7 offen offset:1024  lds
    buffer_load_dwordx4 v18, s[16:19], s7 offen offset:2048  lds
    s_waitcnt vmcnt(12)
    s_barrier
    s_add_u32 m0, s6, 36864
    s_add_u32 s7, s4, 1769856
    buffer_load_dwordx4 v16, s[16:19], s7 offen offset:0  lds
    s_load_dword s2, s[28:29], 10240
    buffer_load_dwordx4 v17, s[16:19], s7 offen offset:1024  lds
    buffer_load_dwordx4 v18, s[16:19], s7 offen offset:2048  lds
    s_waitcnt vmcnt(12)
    s_barrier
    s_add_u32 m0, s6, 49152
    s_add_u32 s7, s4, 2064768
    buffer_load_dwordx4 v16, s[16:19], s7 offen offset:0  lds
    s_load_dword s2, s[28:29], 10496
    buffer_load_dwordx4 v17, s[16:19], s7 offen offset:1024  lds
    buffer_load_dwordx4 v18, s[16:19], s7 offen offset:2048  lds
    s_waitcnt vmcnt(12)
    s_barrier
    s_add_u32 m0, s6, 61440
    s_add_u32 s7, s4, 2359680
    buffer_load_dwordx4 v16, s[16:19], s7 offen offset:0  lds
    s_load_dword s2, s[28:29], 11520
    buffer_load_dwordx4 v17, s[16:19], s7 offen offset:1024  lds
    buffer_load_dwordx4 v18, s[16:19], s7 offen offset:2048  lds
    ds_read_b64 v[36:37], v11 offset:0
    ds_read_b64 v[38:39], v11 offset:256
    ds_read_b64 v[40:41], v11 offset:24576
    ds_read_b64 v[42:43], v11 offset:24832
    ds_read_b64 v[44:45], v11 offset:49152
    ds_read_b64 v[46:47], v11 offset:49408
    s_waitcnt vmcnt(12)
    s_barrier
    s_add_u32 m0, s6, 73728
    s_add_u32 s7, s4, 2654592
    buffer_load_dwordx4 v16, s[16:19], s7 offen offset:0  lds
    s_load_dword s2, s[28:29], 11776
    buffer_load_dwordx4 v17, s[16:19], s7 offen offset:1024  lds
    buffer_load_dwordx4 v18, s[16:19], s7 offen offset:2048  lds
    s_waitcnt vmcnt(12)
    s_barrier
    s_add_u32 m0, s6, 0
    s_add_u32 s7, s4, 2949504
    buffer_load_dwordx4 v16, s[16:19], s7 offen offset:0  lds
    s_load_dword s2, s[28:29], 12544
    buffer_load_dwordx4 v17, s[16:19], s7 offen offset:1024  lds
    buffer_load_dwordx4 v18, s[16:19], s7 offen offset:2048  lds
    s_waitcnt vmcnt(12)
    s_barrier
    s_add_u32 m0, s6, 12288
    s_add_u32 s7, s4, 3244416
    buffer_load_dwordx4 v16, s[16:19], s7 offen offset:0  lds
    s_load_dword s2, s[28:29], 12800
    buffer_load_dwordx4 v17, s[16:19], s7 offen offset:1024  lds
    buffer_load_dwordx4 v18, s[16:19], s7 offen offset:2048  lds
    s_waitcnt vmcnt(12)
    s_barrier
    s_add_u32 m0, s6, 24576
    s_add_u32 s7, s4, 3539328
    buffer_load_dwordx4 v16, s[16:19], s7 offen offset:0  lds
    s_load_dword s2, s[28:29], 13824
    buffer_load_dwordx4 v17, s[16:19], s7 offen offset:1024  lds
    buffer_load_dwordx4 v18, s[16:19], s7 offen offset:2048  lds
    s_waitcnt vmcnt(12)
    s_barrier
    s_add_u32 m0, s6, 36864
    s_add_u32 s7, s4, 3834240
    buffer_load_dwordx4 v16, s[16:19], s7 offen offset:0  lds
    s_load_dword s2, s[28:29], 14080
    buffer_load_dwordx4 v17, s[16:19], s7 offen offset:1024  lds
    buffer_load_dwordx4 v18, s[16:19], s7 offen offset:2048  lds
    s_waitcnt vmcnt(12)
    s_barrier
    s_add_u32 m0, s6, 49152
    s_add_u32 s7, s4, 4129152
    buffer_load_dwordx4 v16, s[16:19], s7 offen offset:0  lds
    s_load_dword s2, s[28:29], 14848
    buffer_load_dwordx4 v17, s[16:19], s7 offen offset:1024  lds
    buffer_load_dwordx4 v18, s[16:19], s7 offen offset:2048  lds
    s_waitcnt vmcnt(12)
    s_barrier
    s_add_u32 m0, s6, 61440
    s_add_u32 s7, s4, 4424064
    buffer_load_dwordx4 v16, s[16:19], s7 offen offset:0  lds
    s_load_dword s2, s[28:29], 15104
    buffer_load_dwordx4 v17, s[16:19], s7 offen offset:1024  lds
    buffer_load_dwordx4 v18, s[16:19], s7 offen offset:2048  lds
    s_waitcnt vmcnt(12)
    s_barrier
    s_add_u32 m0, s6, 73728
    s_add_u32 s7, s4, 4718976
    buffer_load_dwordx4 v16, s[16:19], s7 offen offset:0  lds
    s_load_dword s2, s[28:29], 16128
    buffer_load_dwordx4 v17, s[16:19], s7 offen offset:1024  lds
    buffer_load_dwordx4 v18, s[16:19], s7 offen offset:2048  lds
    s_waitcnt vmcnt(12)
    s_barrier
    s_add_u32 m0, s6, 0
    s_add_u32 s7, s4, 5013888
    buffer_load_dwordx4 v16, s[16:19], s7 offen offset:0  lds
    s_load_dword s2, s[28:29], 16384
    buffer_load_dwordx4 v17, s[16:19], s7 offen offset:1024  lds
    buffer_load_dwordx4 v18, s[16:19], s7 offen offset:2048  lds
    s_waitcnt vmcnt(12)
    s_barrier
    s_add_u32 m0, s6, 12288
    s_add_u32 s7, s4, 768
    buffer_load_dwordx4 v16, s[16:19], s7 offen offset:0  lds
    s_load_dword s2, s[28:29], 17152
    buffer_load_dwordx4 v17, s[16:19], s7 offen offset:1024  lds
    buffer_load_dwordx4 v18, s[16:19], s7 offen offset:2048  lds
    s_waitcnt vmcnt(12)
    s_barrier
    s_add_u32 m0, s6, 24576
    s_add_u32 s7, s4, 295680
    buffer_load_dwordx4 v16, s[16:19], s7 offen offset:0  lds
    s_load_dword s2, s[28:29], 17408
    buffer_load_dwordx4 v17, s[16:19], s7 offen offset:1024  lds
    buffer_load_dwordx4 v18, s[16:19], s7 offen offset:2048  lds
    s_waitcnt vmcnt(12)
    s_barrier
    s_add_u32 m0, s6, 36864
    s_add_u32 s7, s4, 590592
    buffer_load_dwordx4 v16, s[16:19], s7 offen offset:0  lds
    s_load_dword s2, s[28:29], 18432
    buffer_load_dwordx4 v17, s[16:19], s7 offen offset:1024  lds
    buffer_load_dwordx4 v18, s[16:19], s7 offen offset:2048  lds
    s_waitcnt vmcnt(12)
    s_barrier
    s_add_u32 m0, s6, 49152
    s_add_u32 s7, s4, 885504
    buffer_load_dwordx4 v16, s[16:19], s7 offen offset:0  lds
    s_load_dword s2, s[28:29], 18688
    buffer_load_dwordx4 v17, s[16:19], s7 offen offset:1024  lds
    buffer_load_dwordx4 v18, s[16:19], s7 offen offset:2048  lds
    s_waitcnt vmcnt(12)
    s_barrier
    s_add_u32 m0, s6, 61440
    s_add_u32 s7, s4, 1180416
    buffer_load_dwordx4 v16, s[16:19], s7 offen offset:0  lds
    s_load_dword s2, s[28:29], 19456
    buffer_load_dwordx4 v17, s[16:19], s7 offen offset:1024  lds
    buffer_load_dwordx4 v18, s[16:19], s7 offen offset:2048  lds
    s_waitcnt vmcnt(12)
    s_barrier
    s_add_u32 m0, s6, 73728
    s_add_u32 s7, s4, 1475328
    buffer_load_dwordx4 v16, s[16:19], s7 offen offset:0  lds
    s_load_dword s2, s[28:29], 19712
    buffer_load_dwordx4 v17, s[16:19], s7 offen offset:1024  lds
    buffer_load_dwordx4 v18, s[16:19], s7 offen offset:2048  lds
    s_waitcnt vmcnt(12)
    s_barrier
    s_add_u32 m0, s6, 0
    s_add_u32 s7, s4, 1770240
    buffer_load_dwordx4 v16, s[16:19], s7 offen offset:0  lds
    s_load_dword s2, s[28:29], 512
    buffer_load_dwordx4 v17, s[16:19], s7 offen offset:1024  lds
    buffer_load_dwordx4 v18, s[16:19], s7 offen offset:2048  lds
    s_waitcnt vmcnt(12)
    s_barrier
    s_add_u32 m0, s6, 12288
    s_add_u32 s7, s4, 2065152
    buffer_load_dwordx4 v16, s[16:19], s7 offen offset:0  lds
    s_load_dword s2, s[28:29], 1536
    buffer_load_dwordx4 v17, s[16:19], s7 offen offset:1024  lds
    buffer_load_dwordx4 v18, s[16:19], s7 offen offset:2048  lds
    s_waitcnt vmcnt(12)
    s_barrier
    s_add_u32 m0, s6, 24576
    s_add_u32 s7, s4, 2360064
    buffer_load_dwordx4 v16, s[16:19], s7 offen offset:0  lds
    s_load_dword s2, s[28:29], 1792
    buffer_load_dwordx4 v17, s[16:19], s7 offen offset:1024  lds
    buffer_load_dwordx4 v18, s[16:19], s7 offen offset:2048  lds
    s_waitcnt vmcnt(12)
    s_barrier
    s_add_u32 m0, s6, 36864
    s_add_u32 s7, s4, 2654976
    buffer_load_dwordx4 v16, s[16:19], s7 offen offset:0  lds
    s_load_dword s2, s[28:29], 2816
    buffer_load_dwordx4 v17, s[16:19], s7 offen offset:1024  lds
    buffer_load_dwordx4 v18, s[16:19], s7 offen offset:2048  lds
    s_waitcnt vmcnt(12)
    s_barrier
    s_add_u32 m0, s6, 49152
    s_add_u32 s7, s4, 2949888
    buffer_load_dwordx4 v16, s[16:19], s7 offen offset:0  lds
    s_load_dword s2, s[28:29], 3840
    buffer_load_dwordx4 v17, s[16:19], s7 offen offset:1024  lds
    buffer_load_dwordx4 v18, s[16:19], s7 offen offset:2048  lds
    s_waitcnt vmcnt(12)
    s_barrier
    s_add_u32 m0, s6, 61440
    s_add_u32 s7, s4, 3244800
    buffer_load_dwordx4 v16, s[16:19], s7 offen offset:0  lds
    s_load_dword s2, s[28:29], 4096
    buffer_load_dwordx4 v17, s[16:19], s7 offen offset:1024  lds
    buffer_load_dwordx4 v18, s[16:19], s7 offen offset:2048  lds
    s_waitcnt vmcnt(12)
    s_barrier
    s_add_u32 m0, s6, 73728
    s_add_u32 s7, s4, 3539712
    buffer_load_dwordx4 v16, s[16:19], s7 offen offset:0  lds
    s_load_dword s2, s[28:29], 5120
    buffer_load_dwordx4 v17, s[16:19], s7 offen offset:1024  lds
    buffer_load_dwordx4 v18, s[16:19], s7 offen offset:2048  lds
    s_waitcnt vmcnt(12)
    s_barrier
    s_add_u32 m0, s6, 0
    s_add_u32 s7, s4, 3834624
    buffer_load_dwordx4 v16, s[16:19], s7 offen offset:0  lds
    s_load_dword s2, s[28:29], 6144
    buffer_load_dwordx4 v17, s[16:19], s7 offen offset:1024  lds
    buffer_load_dwordx4 v18, s[16:19], s7 offen offset:2048  lds
    s_waitcnt vmcnt(12)
    s_barrier
    s_add_u32 m0, s6, 12288
    s_add_u32 s7, s4, 4129536
    buffer_load_dwordx4 v16, s[16:19], s7 offen offset:0  lds
    s_load_dword s2, s[28:29], 6400
    buffer_load_dwordx4 v17, s[16:19], s7 offen offset:1024  lds
    buffer_load_dwordx4 v18, s[16:19], s7 offen offset:2048  lds
    s_waitcnt vmcnt(12)
    s_barrier
    s_add_u32 m0, s6, 24576
    s_add_u32 s7, s4, 4424448
    buffer_load_dwordx4 v16, s[16:19], s7 offen offset:0  lds
    s_load_dword s2, s[28:29], 7424
    buffer_load_dwordx4 v17, s[16:19], s7 offen offset:1024  lds
    buffer_load_dwordx4 v18, s[16:19], s7 offen offset:2048  lds
    s_waitcnt vmcnt(12)
    s_barrier
    s_add_u32 m0, s6, 36864
    s_add_u32 s7, s4, 4719360
    buffer_load_dwordx4 v16, s[16:19], s7 offen offset:0  lds
    s_load_dword s2, s[28:29], 8448
    buffer_load_dwordx4 v17, s[16:19], s7 offen offset:1024  lds
    buffer_load_dwordx4 v18, s[16:19], s7 offen offset:2048  lds
    buffer_load_dword v63, v13, s[32:35], 0 offen sc1
    buffer_load_dword v62, v2, s[32:35], 0 offen sc1
    s_waitcnt vmcnt(14)
    s_barrier
    s_add_u32 m0, s6, 49152
    s_add_u32 s7, s4, 5014272
    buffer_load_dwordx4 v16, s[16:19], s7 offen offset:0  lds
    s_load_dword s2, s[28:29], 8704
    buffer_load_dwordx4 v17, s[16:19], s7 offen offset:1024  lds
    buffer_load_dwordx4 v18, s[16:19], s7 offen offset:2048  lds
    s_waitcnt vmcnt(14)
    s_barrier
    s_add_u32 m0, s6, 61440
    s_add_u32 s7, s60, 0
    buffer_load_dwordx4 v20, s[20:23], s7 offen offset:0  lds
    s_load_dword s2, s[28:29], 9728
    buffer_load_dwordx4 v21, s[20:23], s7 offen offset:1024  lds
    buffer_load_dwordx4 v22, s[20:23], s7 offen offset:2048  lds
    s_waitcnt vmcnt(14)
    s_barrier
    s_waitcnt vmcnt(11)
    s_barrier
    s_waitcnt vmcnt(8)
    s_barrier
    s_add_u32 m0, s6, 73728
    s_add_u32 s7, s60, 18432
    buffer_load_dwordx4 v20, s[20:23], s7 offen offset:0  lds
    s_load_dword s2, s[28:29], 10752
    buffer_load_dwordx4 v21, s[20:23], s7 offen offset:1024  lds
    buffer_load_dwordx4 v22, s[20:23], s7 offen offset:2048  lds
    s_add_u32 m0, s6, 0
    s_add_u32 s7, s60, 36864
    buffer_load_dwordx4 v20, s[20:23], s7 offen offset:0  lds
    s_load_dword s2, s[28:29], 11008
    buffer_load_dwordx4 v21, s[20:23], s7 offen offset:1024  lds
    buffer_load_dwordx4 v22, s[20:23], s7 offen offset:2048  lds
    s_waitcnt vmcnt(9)
    s_barrier
    s_add_u32 m0, s6, 12288
    s_add_u32 s7, s60, 55296
    buffer_load_dwordx4 v20, s[20:23], s7 offen offset:0  lds
    s_load_dword s2, s[28:29], 12032
    buffer_load_dwordx4 v21, s[20:23], s7 offen offset:1024  lds
    buffer_load_dwordx4 v22, s[20:23], s7 offen offset:2048  lds
    s_add_u32 m0, s6, 24576
    s_add_u32 s7, s5, 147456
    buffer_load_dwordx4 v20, s[20:23], s7 offen offset:0  lds
    s_load_dword s2, s[28:29], 13056
    buffer_load_dwordx4 v21, s[20:23], s7 offen offset:1024  lds
    buffer_load_dwordx4 v22, s[20:23], s7 offen offset:2048  lds
    v_cmp_ne_u32 vcc, s12, v63
    s_cbranch_vccz lz_ok
lz:
    s_sleep 4
    buffer_load_dword v63, v13, s[32:35], 0 offen sc1
    s_waitcnt vmcnt(0)
    v_cmp_ne_u32 vcc, s12, v63
    s_cbranch_vccz lz_ok
    s_sub_u32 s3, s3, 1
    s_cbranch_scc0 lz
lz_ok:
    buffer_load_dword v48, v4, s[32:35], s9 offen sc1
    buffer_load_dword v49, v12, s[32:35], s9 offen sc1
    buffer_load_dword v50, v8, s[32:35], s9 offen sc1
    buffer_load_dword v51, v6, s[32:35], s9 offen sc1
    s_add_u32 s9, s9, 786432
    buffer_load_dword v52, v4, s[32:35], s9 offen sc1
    buffer_load_dword v53, v12, s[32:35], s9 offen sc1
    buffer_load_dword v54, v8, s[32:35], s9 offen sc1
    buffer_load_dword v55, v6, s[32:35], s9 offen sc1
    s_add_u32 s9, s9, 786432
    buffer_load_dword v56, v4, s[32:35], s9 offen sc1
    buffer_load_dword v57, v12, s[32:35], s9 offen sc1
    buffer_load_dword v58, v8, s[32:35], s9 offen sc1
    buffer_load_dword v59, v6, s[32:35], s9 offen sc1
    s_add_u32 s9, s9, 786432
    s_waitcnt vmcnt(24)
    s_barrier
    s_add_u32 m0, s6, 36864
    s_add_u32 s7, s5, 184320
    buffer_load_dwordx4 v20, s[20:23], s7 offen offset:0  lds
    s_load_dword s2, s[28:29], 13312
    buffer_load_dwordx4 v21, s[20:23], s7 offen offset:1024  lds
    buffer_load_dwordx4 v22, s[20:23], s7 offen offset:2048  lds
    s_waitcnt vmcnt(24)
    s_barrier
    s_add_u32 m0, s6, 49152
    s_add_u32 s7, s60, 221184
    buffer_load_dwordx4 v20, s[20:23], s7 offen offset:0  lds
    s_load_dword s2, s[28:29], 14336
    buffer_load_dwordx4 v21, s[20:23], s7 offen offset:1024  lds
    buffer_load_dwordx4 v22, s[20:23], s7 offen offset:2048  lds
    s_waitcnt vmcnt(24)
    s_barrier
    s_add_u32 m0, s6, 61440
    s_add_u32 s7, s60, 239616
    buffer_load_dwordx4 v20, s[20:23], s7 offen offset:0  lds
    s_load_dword s2, s[28:29], 15360
    buffer_load_dwordx4 v21, s[20:23], s7 offen offset:1024  lds
    buffer_load_dwordx4 v22, s[20:23], s7 offen offset:2048  lds
    s_waitcnt vmcnt(24)
    s_barrier
    s_add_u32 m0, s6, 73728
    s_add_u32 s7, s60, 258048
    buffer_load_dwordx4 v20, s[20:23], s7 offen offset:0  lds
    s_load_dword s2, s[28:29], 15616
    buffer_load_dwordx4 v21, s[20:23], s7 offen offset:1024  lds
    buffer_load_dwordx4 v22, s[20:23], s7 offen offset:2048  lds
    s_waitcnt vmcnt(24)
    s_barrier
    s_add_u32 m0, s6, 0
    s_add_u32 s7, s60, 276480
    buffer_load_dwordx4 v20, s[20:23], s7 offen offset:0  lds
    s_load_dword s2, s[28:29], 16640
    buffer_load_dwordx4 v21, s[20:23], s7 offen offset:1024  lds
    buffer_load_dwordx4 v22, s[20:23], s7 offen offset:2048  lds
    s_waitcnt vmcnt(12)
    s_barrier
    s_add_u32 m0, s6, 12288
    s_add_u32 s7, s5, 368640
    buffer_load_dwordx4 v20, s[20:23], s7 offen offset:0  lds
    s_load_dword s2, s[28:29], 17664
    buffer_load_dwordx4 v21, s[20:23], s7 offen offset:1024  lds
    buffer_load_dwordx4 v22, s[20:23], s7 offen offset:2048  lds
    s_waitcnt vmcnt(12)
    s_barrier
    s_add_u32 m0, s6, 24576
    s_add_u32 s7, s5, 405504
    buffer_load_dwordx4 v20, s[20:23], s7 offen offset:0  lds
    s_load_dword s2, s[28:29], 17920
    buffer_load_dwordx4 v21, s[20:23], s7 offen offset:1024  lds
    buffer_load_dwordx4 v22, s[20:23], s7 offen offset:2048  lds
    s_waitcnt vmcnt(12)
    s_barrier
    s_add_u32 m0, s6, 36864
    s_add_u32 s7, s60, 442368
    buffer_load_dwordx4 v20, s[20:23], s7 offen offset:0  lds
    s_load_dword s2, s[28:29], 18944
    buffer_load_dwordx4 v21, s[20:23], s7 offen offset:1024  lds
    buffer_load_dwordx4 v22, s[20:23], s7 offen offset:2048  lds
    s_waitcnt vmcnt(12)
    s_barrier
    s_add_u32 m0, s6, 49152
    s_add_u32 s7, s60, 460800
    buffer_load_dwordx4 v20, s[20:23], s7 offen offset:0  lds
    s_load_dword s2, s[28:29], 19968
    buffer_load_dwordx4 v21, s[20:23], s7 offen offset:1024  lds
    buffer_load_dwordx4 v22, s[20:23], s7 offen offset:2048  lds
    s_waitcnt vmcnt(12)
    s_barrier
    s_add_u32 m0, s6, 61440
    s_add_u32 s7, s60, 479232
    buffer_load_dwordx4 v20, s[20:23], s7 offen offset:0  lds
    s_load_dword s2, s[28:29], 20224
    buffer_load_dwordx4 v21, s[20:23], s7 offen offset:1024  lds
    buffer_load_dwordx4 v22, s[20:23], s7 offen offset:2048  lds
    s_waitcnt vmcnt(12)
    s_barrier
    s_waitcnt vmcnt(9)
    s_barrier
    s_add_u32 m0, s6, 73728
    s_add_u32 s7, s60, 497664
    buffer_load_dwordx4 v20, s[20:23], s7 offen offset:0  lds
    s_load_dword s2, s[28:29], 768
    buffer_load_dwordx4 v21, s[20:23], s7 offen offset:1024  lds
    buffer_load_dwordx4 v22, s[20:23], s7 offen offset:2048  lds
    s_add_u32 m0, s6, 0
    s_add_u32 s7, s5, 589824
    buffer_load_dwordx4 v20, s[20:23], s7 offen offset:0  lds
    s_load_dword s2, s[28:29], 2048
    buffer_load_dwordx4 v21, s[20:23], s7 offen offset:1024  lds
    buffer_load_dwordx4 v22, s[20:23], s7 offen offset:2048  lds
    s_waitcnt vmcnt(12)
    s_barrier
    s_add_u32 m0, s6, 12288
    s_add_u32 s7, s5, 626688
    buffer_load_dwordx4 v20, s[20:23], s7 offen offset:0  lds
    s_load_dword s2, s[28:29], 3072
    buffer_load_dwordx4 v21, s[20:23], s7 offen offset:1024  lds
    buffer_load_dwordx4 v22, s[20:23], s7 offen offset:2048  lds
    s_waitcnt vmcnt(12)
    s_barrier
    s_add_u32 m0, s6, 24576
    s_add_u32 s7, s60, 384
    buffer_load_dwordx4 v20, s[20:23], s7 offen offset:0  lds
    s_load_dword s2, s[28:29], 4352
    buffer_load_dwordx4 v21, s[20:23], s7 offen offset:1024  lds
    buffer_load_dwordx4 v22, s[20:23], s7 offen offset:2048  lds
    s_waitcnt vmcnt(12)
    s_barrier
    s_waitcnt vmcnt(9)
    s_barrier
    s_add_u32 m0, s6, 36864
    s_add_u32 s7, s60, 18816
    buffer_load_dwordx4 v20, s[20:23], s7 offen offset:0  lds
    s_load_dword s2, s[28:29], 5376
    buffer_load_dwordx4 v21, s[20:23], s7 offen offset:1024  lds
    buffer_load_dwordx4 v22, s[20:23], s7 offen offset:2048  lds
    s_add_u32 m0, s6, 49152
    s_add_u32 s7, s60, 37248
    buffer_load_dwordx4 v20, s[20:23], s7 offen offset:0  lds
    s_load_dword s2, s[28:29], 6656
    buffer_load_dwordx4 v21, s[20:23], s7 offen offset:1024  lds
    buffer_load_dwordx4 v22, s[20:23], s7 offen offset:2048  lds
    s_waitcnt vmcnt(12)
    s_barrier
    s_add_u32 m0, s6, 61440
    s_add_u32 s7, s60, 55680
    buffer_load_dwordx4 v20, s[20:23], s7 offen offset:0  lds
    s_load_dword s2, s[28:29], 7680
    buffer_load_dwordx4 v21, s[20:23], s7 offen offset:1024  lds
    buffer_load_dwordx4 v22, s[20:23], s7 offen offset:2048  lds
    s_waitcnt vmcnt(12)
    s_barrier
    s_add_u32 m0, s6, 73728
    s_add_u32 s7, s5, 147840
    buffer_load_dwordx4 v20, s[20:23], s7 offen offset:0  lds
    s_load_dword s2, s[28:29], 8960
    buffer_load_dwordx4 v21, s[20:23], s7 offen offset:1024  lds
    buffer_load_dwordx4 v22, s[20:23], s7 offen offset:2048  lds
    s_waitcnt vmcnt(12)
    s_barrier
    s_add_u32 m0, s6, 0
    s_add_u32 s7, s5, 184704
    buffer_load_dwordx4 v20, s[20:23], s7 offen offset:0  lds
    s_load_dword s2, s[28:29], 9984
    buffer_load_dwordx4 v21, s[20:23], s7 offen offset:1024  lds
    buffer_load_dwordx4 v22, s[20:23], s7 offen offset:2048  lds
    s_waitcnt vmcnt(12)
    s_barrier
    s_add_u32 m0, s6, 12288
    s_add_u32 s7, s60, 221568
    buffer_load_dwordx4 v20, s[20:23], s7 offen offset:0  lds
    s_load_dword s2, s[28:29], 11264
    buffer_load_dwordx4 v21, s[20:23], s7 offen offset:1024  lds
    buffer_load_dwordx4 v22, s[20:23], s7 offen offset:2048  lds
    s_waitcnt vmcnt(12)
    s_barrier
    s_add_u32 m0, s6, 24576
    s_add_u32 s7, s60, 240000
    buffer_load_dwordx4 v20, s[20:23], s7 offen offset:0  lds
    s_load_dword s2, s[28:29], 12288
    buffer_load_dwordx4 v21, s[20:23], s7 offen offset:1024  lds
    buffer_load_dwordx4 v22, s[20:23], s7 offen offset:2048  lds
    s_waitcnt vmcnt(12)
    s_barrier
    s_add_u32 m0, s6, 36864
    s_add_u32 s7, s60, 258432
    buffer_load_dwordx4 v20, s[20:23], s7 offen offset:0  lds
    s_load_dword s2, s[28:29], 13568
    buffer_load_dwordx4 v21, s[20:23], s7 offen offset:1024  lds
    buffer_load_dwordx4 v22, s[20:23], s7 offen offset:2048  lds
    s_waitcnt vmcnt(12)
    s_barrier
    s_add_u32 m0, s6, 49152
    s_add_u32 s7, s60, 276864
    buffer_load_dwordx4 v20, s[20:23], s7 offen offset:0  lds
    s_load_dword s2, s[28:29], 14592
    buffer_load_dwordx4 v21, s[20:23], s7 offen offset:1024  lds
    buffer_load_dwordx4 v22, s[20:23], s7 offen offset:2048  lds
    s_waitcnt vmcnt(12)
    s_barrier
    s_add_u32 m0, s6, 61440
    s_add_u32 s7, s5, 369024
    buffer_load_dwordx4 v20, s[20:23], s7 offen offset:0  lds
    s_load_dword s2, s[28:29], 15872
    buffer_load_dwordx4 v21, s[20:23], s7 offen offset:1024  lds
    buffer_load_dwordx4 v22, s[20:23], s7 offen offset:2048  lds
    s_waitcnt vmcnt(12)
    s_barrier
    s_add_u32 m0, s6, 73728
    s_add_u32 s7, s5, 405888
    buffer_load_dwordx4 v20, s[20:23], s7 offen offset:0  lds
    s_load_dword s2, s[28:29], 16896
    buffer_load_dwordx4 v21, s[20:23], s7 offen offset:1024  lds
    buffer_load_dwordx4 v22, s[20:23], s7 offen offset:2048  lds
    s_waitcnt vmcnt(12)
    s_barrier
    s_add_u32 m0, s6, 0
    s_add_u32 s7, s60, 442752
    buffer_load_dwordx4 v20, s[20:23], s7 offen offset:0  lds
    v_lshlrev_b32 v96, 16, v24
    v_and_b32 v97, 0xffff0000, v24
    v_lshlrev_b32 v98, 16, v25
    v_and_b32 v99, 0xffff0000, v25
    v_lshlrev_b32 v100, 16, v26
    v_and_b32 v101, 0xffff0000, v26
    v_lshlrev_b32 v102, 16, v27
    v_and_b32 v103, 0xffff0000, v27
    s_load_dword s2, s[28:29], 18176
    buffer_load_dwordx4 v21, s[20:23], s7 offen offset:1024  lds
    v_lshlrev_b32 v104, 16, v48
    v_and_b32 v105, 0xffff0000, v48
    v_lshlrev_b32 v106, 16, v49
    v_and_b32 v107, 0xffff0000, v49
    v_lshlrev_b32 v108, 16, v50
    v_and_b32 v109, 0xffff0000, v50
    v_lshlrev_b32 v110, 16, v51
    v_and_b32 v111, 0xffff0000, v51
    buffer_load_dwordx4 v22, s[20:23], s7 offen offset:2048  lds
    s_waitcnt vmcnt(12)
    s_barrier
    s_add_u32 m0, s6, 12288
    s_add_u32 s7, s60, 461184
    buffer_load_dwordx4 v20, s[20:23], s7 offen offset:0  lds
    v_mul_f32 v96, v96, v104
    v_mul_f32 v97, v97, v105
    v_mul_f32 v98, v98, v106
    v_mul_f32 v99, v99, v107
    v_mul_f32 v100, v100, v108
    v_mul_f32 v101, v101, v109
    v_mul_f32 v102, v102, v110
    v_mul_f32 v103, v103, v111
    s_load_dword s2, s[28:29], 19200
    buffer_load_dwordx4 v21, s[20:23], s7 offen offset:1024  lds
    v_cvt_pk_bf16_f32 v104, v96, v97
    v_cvt_pk_bf16_f32 v105, v98, v99
    v_cvt_pk_bf16_f32 v106, v100, v101
    v_cvt_pk_bf16_f32 v107, v102, v103
    v_lshlrev_b32 v96, 16, v104
    v_and_b32 v97, 0xffff0000, v104
    v_lshlrev_b32 v98, 16, v105
    v_and_b32 v99, 0xffff0000, v105
    buffer_load_dwordx4 v22, s[20:23], s7 offen offset:2048  lds
    s_waitcnt vmcnt(12)
    s_barrier
    s_add_u32 m0, s6, 24576
    s_add_u32 s7, s60, 479616
    buffer_load_dwordx4 v20, s[20:23], s7 offen offset:0  lds
    v_lshlrev_b32 v100, 16, v106
    v_and_b32 v101, 0xffff0000, v106
    v_lshlrev_b32 v102, 16, v107
    v_and_b32 v103, 0xffff0000, v107
    v_mul_f32 v96, v62, v96
    v_mul_f32 v97, v62, v97
    v_mul_f32 v98, v62, v98
    v_mul_f32 v99, v62, v99
    s_load_dword s2, s[28:29], 20480
    buffer_load_dwordx4 v21, s[20:23], s7 offen offset:1024  lds
    v_mul_f32 v100, v62, v100
    v_mul_f32 v101, v62, v101
    v_mul_f32 v102, v62, v102
    v_mul_f32 v103, v62, v103
    v_cvt_pk_bf16_f32 v24, v96, v97
    v_cvt_pk_bf16_f32 v25, v98, v99
    v_cvt_pk_bf16_f32 v26, v100, v101
    v_cvt_pk_bf16_f32 v27, v102, v103
    buffer_load_dwordx4 v22, s[20:23], s7 offen offset:2048  lds
    s_waitcnt vmcnt(12)
    s_barrier
    s_add_u32 m0, s6, 36864
    s_add_u32 s7, s60, 498048
    buffer_load_dwordx4 v20, s[20:23], s7 offen offset:0  lds
    v_lshlrev_b32 v96, 16, v28
    v_and_b32 v97, 0xffff0000, v28
    v_lshlrev_b32 v98, 16, v29
    v_and_b32 v99, 0xffff0000, v29
    v_lshlrev_b32 v100, 16, v30
    v_and_b32 v101, 0xffff0000, v30
    v_lshlrev_b32 v102, 16, v31
    v_and_b32 v103, 0xffff0000, v31
    buffer_load_dwordx4 v21, s[20:23], s7 offen offset:1024  lds
    v_lshlrev_b32 v104, 16, v52
    v_and_b32 v105, 0xffff0000, v52
    v_lshlrev_b32 v106, 16, v53
    v_and_b32 v107, 0xffff0000, v53
    v_lshlrev_b32 v108, 16, v54
    v_and_b32 v109, 0xffff0000, v54
    v_lshlrev_b32 v110, 16, v55
    v_and_b32 v111, 0xffff0000, v55
    buffer_load_dwordx4 v22, s[20:23], s7 offen offset:2048  lds
    s_waitcnt vmcnt(12)
    s_barrier
    s_add_u32 m0, s6, 49152
    s_add_u32 s7, s5, 590208
    buffer_load_dwordx4 v20, s[20:23], s7 offen offset:0  lds
    v_mul_f32 v96, v96, v104
    v_mul_f32 v97, v97, v105
    v_mul_f32 v98, v98, v106
    v_mul_f32 v99, v99, v107
    v_mul_f32 v100, v100, v108
    v_mul_f32 v101, v101, v109
    v_mul_f32 v102, v102, v110
    v_mul_f32 v103, v103, v111
    buffer_load_dwordx4 v21, s[20:23], s7 offen offset:1024  lds
    v_cvt_pk_bf16_f32 v104, v96, v97
    v_cvt_pk_bf16_f32 v105, v98, v99
    v_cvt_pk_bf16_f32 v106, v100, v101
    v_cvt_pk_bf16_f32 v107, v102, v103
    v_lshlrev_b32 v96, 16, v104
    v_and_b32 v97, 0xffff0000, v104
    v_lshlrev_b32 v98, 16, v105
    v_and_b32 v99, 0xffff0000, v105
    buffer_load_dwordx4 v22, s[20:23], s7 offen offset:2048  lds
    s_waitcnt vmcnt(12)
    s_barrier
    s_add_u32 m0, s6, 61440
    s_add_u32 s7, s5, 627072
    buffer_load_dwordx4 v20, s[20:23], s7 offen offset:0  lds
    v_lshlrev_b32 v100, 16, v106
    v_and_b32 v101, 0xffff0000, v106
    v_lshlrev_b32 v102, 16, v107
    v_and_b32 v103, 0xffff0000, v107
    v_mul_f32 v96, v62, v96
    v_mul_f32 v97, v62, v97
    v_mul_f32 v98, v62, v98
    v_mul_f32 v99, v62, v99
    buffer_load_dwordx4 v21, s[20:23], s7 offen offset:1024  lds
    v_mul_f32 v100, v62, v100
    v_mul_f32 v101, v62, v101
    v_mul_f32 v102, v62, v102
    v_mul_f32 v103, v62, v103
    v_cvt_pk_bf16_f32 v28, v96, v97
    v_cvt_pk_bf16_f32 v29, v98, v99
    v_cvt_pk_bf16_f32 v30, v100, v101
    v_cvt_pk_bf16_f32 v31, v102, v103
    buffer_load_dwordx4 v22, s[20:23], s7 offen offset:2048  lds
    s_waitcnt vmcnt(12)
    s_barrier
    s_add_u32 m0, s6, 73728
    s_add_u32 s7, s60, 768
    buffer_load_dwordx4 v20, s[20:23], s7 offen offset:0  lds
    v_lshlrev_b32 v96, 16, v32
    v_and_b32 v97, 0xffff0000, v32
    v_lshlrev_b32 v98, 16, v33
    v_and_b32 v99, 0xffff0000, v33
    v_lshlrev_b32 v100, 16, v34
    v_and_b32 v101, 0xffff0000, v34
    v_lshlrev_b32 v102, 16, v35
    v_and_b32 v103, 0xffff0000, v35
    buffer_load_dwordx4 v21, s[20:23], s7 offen offset:1024  lds
    v_lshlrev_b32 v104, 16, v56
    v_and_b32 v105, 0xffff0000, v56
    v_lshlrev_b32 v106, 16, v57
    v_and_b32 v107, 0xffff0000, v57
    v_lshlrev_b32 v108, 16, v58
    v_and_b32 v109, 0xffff0000, v58
    v_lshlrev_b32 v110, 16, v59
    v_and_b32 v111, 0xffff0000, v59
    buffer_load_dwordx4 v22, s[20:23], s7 offen offset:2048  lds
    s_waitcnt vmcnt(12)
    s_barrier
    s_add_u32 m0, s6, 0
    s_add_u32 s7, s60, 19200
    buffer_load_dwordx4 v20, s[20:23], s7 offen offset:0  lds
    v_mul_f32 v96, v96, v104
    v_mul_f32 v97, v97, v105
    v_mul_f32 v98, v98, v106
    v_mul_f32 v99, v99, v107
    v_mul_f32 v100, v100, v108
    v_mul_f32 v101, v101, v109
    v_mul_f32 v102, v102, v110
    v_mul_f32 v103, v103, v111
    buffer_load_dwordx4 v21, s[20:23], s7 offen offset:1024  lds
    v_cvt_pk_bf16_f32 v104, v96, v97
    v_cvt_pk_bf16_f32 v105, v98, v99
    v_cvt_pk_bf16_f32 v106, v100, v101
    v_cvt_pk_bf16_f32 v107, v102, v103
    v_lshlrev_b32 v96, 16, v104
    v_and_b32 v97, 0xffff0000, v104
    v_lshlrev_b32 v98, 16, v105
    v_and_b32 v99, 0xffff0000, v105
    buffer_load_dwordx4 v22, s[20:23], s7 offen offset:2048  lds
    s_waitcnt vmcnt(12)
    s_barrier
    s_add_u32 m0, s6, 12288
    s_add_u32 s7, s60, 37632
    buffer_load_dwordx4 v20, s[20:23], s7 offen offset:0  lds
    v_lshlrev_b32 v100, 16, v106
    v_and_b32 v101, 0xffff0000, v106
    v_lshlrev_b32 v102, 16, v107
    v_and_b32 v103, 0xffff0000, v107
    v_mul_f32 v96, v62, v96
    v_mul_f32 v97, v62, v97
    v_mul_f32 v98, v62, v98
    v_mul_f32 v99, v62, v99
    buffer_load_dwordx4 v21, s[20:23], s7 offen offset:1024  lds
    v_mul_f32 v100, v62, v100
    v_mul_f32 v101, v62, v101
    v_mul_f32 v102, v62, v102
    v_mul_f32 v103, v62, v103
    v_cvt_pk_bf16_f32 v32, v96, v97
    v_cvt_pk_bf16_f32 v33, v98, v99
    v_cvt_pk_bf16_f32 v34, v100, v101
    v_cvt_pk_bf16_f32 v35, v102, v103
    buffer_load_dwordx4 v22, s[20:23], s7 offen offset:2048  lds
    s_waitcnt vmcnt(12)
    s_barrier
    s_add_u32 m0, s6, 24576
    s_add_u32 s7, s60, 56064
    buffer_load_dwordx4 v20, s[20:23], s7 offen offset:0  lds
    buffer_load_dwordx4 v21, s[20:23], s7 offen offset:1024  lds
    buffer_load_dwordx4 v22, s[20:23], s7 offen offset:2048  lds
    s_waitcnt vmcnt(12)
    s_barrier
    s_add_u32 m0, s6, 36864
    s_add_u32 s7, s5, 148224
    buffer_load_dwordx4 v20, s[20:23], s7 offen offset:0  lds
    buffer_load_dwordx4 v21, s[20:23], s7 offen offset:1024  lds
    buffer_load_dwordx4 v22, s[20:23], s7 offen offset:2048  lds
    s_waitcnt vmcnt(12)
    s_barrier
    s_add_u32 m0, s6, 49152
    s_add_u32 s7, s5, 185088
    buffer_load_dwordx4 v20, s[20:23], s7 offen offset:0  lds
    buffer_load_dwordx4 v21, s[20:23], s7 offen offset:1024  lds
    buffer_load_dwordx4 v22, s[20:23], s7 offen offset:2048  lds
    s_waitcnt vmcnt(12)
    s_barrier
    s_add_u32 m0, s6, 61440
    s_add_u32 s7, s60, 221952
    buffer_load_dwordx4 v20, s[20:23], s7 offen offset:0  lds
    buffer_load_dwordx4 v21, s[20:23], s7 offen offset:1024  lds
    buffer_load_dwordx4 v22, s[20:23], s7 offen offset:2048  lds
    s_waitcnt vmcnt(12)
    s_barrier
    s_add_u32 m0, s6, 73728
    s_add_u32 s7, s60, 240384
    buffer_load_dwordx4 v20, s[20:23], s7 offen offset:0  lds
    buffer_load_dwordx4 v21, s[20:23], s7 offen offset:1024  lds
    buffer_load_dwordx4 v22, s[20:23], s7 offen offset:2048  lds
    buffer_load_dword v63, v5, s[32:35], s10 offen sc1
    s_waitcnt vmcnt(13)
    s_barrier
    s_add_u32 m0, s6, 0
    s_add_u32 s7, s60, 258816
    buffer_load_dwordx4 v20, s[20:23], s7 offen offset:0  lds
    buffer_load_dwordx4 v21, s[20:23], s7 offen offset:1024  lds
    buffer_load_dwordx4 v22, s[20:23], s7 offen offset:2048  lds
    s_waitcnt vmcnt(13)
    s_barrier
    s_add_u32 m0, s6, 12288
    s_add_u32 s7, s60, 277248
    buffer_load_dwordx4 v20, s[20:23], s7 offen offset:0  lds
    buffer_load_dwordx4 v21, s[20:23], s7 offen offset:1024  lds
    buffer_load_dwordx4 v22, s[20:23], s7 offen offset:2048  lds
    s_waitcnt vmcnt(13)
    s_barrier
    s_add_u32 m0, s6, 24576
    s_add_u32 s7, s5, 369408
    buffer_load_dwordx4 v20, s[20:23], s7 offen offset:0  lds
    buffer_load_dwordx4 v21, s[20:23], s7 offen offset:1024  lds
    buffer_load_dwordx4 v22, s[20:23], s7 offen offset:2048  lds
    s_waitcnt vmcnt(13)
    s_barrier
    s_add_u32 m0, s6, 36864
    s_add_u32 s7, s5, 406272
    buffer_load_dwordx4 v20, s[20:23], s7 offen offset:0  lds
    buffer_load_dwordx4 v21, s[20:23], s7 offen offset:1024  lds
    buffer_load_dwordx4 v22, s[20:23], s7 offen offset:2048  lds
    s_waitcnt vmcnt(13)
    s_barrier
    s_add_u32 m0, s6, 49152
    s_add_u32 s7, s60, 443136
    buffer_load_dwordx4 v20, s[20:23], s7 offen offset:0  lds
    buffer_load_dwordx4 v21, s[20:23], s7 offen offset:1024  lds
    buffer_load_dwordx4 v22, s[20:23], s7 offen offset:2048  lds
    s_waitcnt vmcnt(12)
    s_barrier
    s_add_u32 m0, s6, 61440
    s_add_u32 s7, s60, 461568
    buffer_load_dwordx4 v20, s[20:23], s7 offen offset:0  lds
    buffer_load_dwordx4 v21, s[20:23], s7 offen offset:1024  lds
    buffer_load_dwordx4 v22, s[20:23], s7 offen offset:2048  lds
    v_cmp_ne_u32 vcc, s12, v63
    s_cbranch_vccz lp0_ok
lp0:
    s_sleep 4
    buffer_load_dword v63, v5, s[32:35], s10 offen sc1
    s_waitcnt vmcnt(0)
    v_cmp_ne_u32 vcc, s12, v63
    s_cbranch_vccz lp0_ok
    s_sub_u32 s3, s3, 1
    s_cbranch_scc0 lp0
lp0_ok:
    s_add_u32 s14, s11, 4096
    buffer_load_dwordx4 v[64:67], v7, s[32:35], s11 offen offset:0 sc1
    buffer_load_dwordx4 v[68:71], v7, s[32:35], s11 offen offset:1024 sc1
    buffer_load_dwordx4 v[72:75], v7, s[32:35], s11 offen offset:2048 sc1
    buffer_load_dwordx4 v[76:79], v7, s[32:35], s11 offen offset:3072 sc1
    buffer_load_dwordx4 v[80:83], v7, s[32:35], s14 offen offset:0 sc1
    buffer_load_dwordx4 v[84:87], v7, s[32:35], s14 offen offset:1024 sc1
    buffer_load_dwordx4 v[88:91], v7, s[32:35], s14 offen offset:2048 sc1
    buffer_load_dwordx4 v[92:95], v7, s[32:35], s14 offen offset:3072 sc1
    s_add_u32 s11, s11, 196608
    s_add_u32 s10, s10, 128
    s_waitcnt vmcnt(20)
    s_barrier
    s_add_u32 m0, s6, 73728
    s_add_u32 s7, s60, 480000
    buffer_load_dwordx4 v20, s[20:23], s7 offen offset:0  lds
    buffer_load_dwordx4 v21, s[20:23], s7 offen offset:1024  lds
    buffer_load_dwordx4 v22, s[20:23], s7 offen offset:2048  lds
    s_waitcnt vmcnt(20)
    s_barrier
    s_add_u32 m0, s6, 0
    s_add_u32 s7, s60, 498432
    buffer_load_dwordx4 v20, s[20:23], s7 offen offset:0  lds
    buffer_load_dwordx4 v21, s[20:23], s7 offen offset:1024  lds
    buffer_load_dwordx4 v22, s[20:23], s7 offen offset:2048  lds
    s_waitcnt vmcnt(20)
    s_barrier
    s_add_u32 m0, s6, 12288
    s_add_u32 s7, s5, 590592
    buffer_load_dwordx4 v20, s[20:23], s7 offen offset:0  lds
    buffer_load_dwordx4 v21, s[20:23], s7 offen offset:1024  lds
    buffer_load_dwordx4 v22, s[20:23], s7 offen offset:2048  lds
    s_waitcnt vmcnt(20)
    s_barrier
    s_add_u32 m0, s6, 24576
    s_add_u32 s7, s5, 627456
    buffer_load_dwordx4 v20, s[20:23], s7 offen offset:0  lds
    buffer_load_dwordx4 v21, s[20:23], s7 offen offset:1024  lds
    buffer_load_dwordx4 v22, s[20:23], s7 offen offset:2048  lds
    buffer_load_dword v63, v5, s[32:35], s10 offen sc1
    s_waitcnt vmcnt(21)
    s_barrier
    s_waitcnt vmcnt(0)
    s_barrier
    s_setprio 0
    s_cmp_eq_u32 s59, 3
    s_cbranch_scc1 k3_done_x
    v_cmp_ne_u32 vcc, s12, v63
    s_cbranch_vccz lp1_ok
lp1:
    s_sleep 4
    buffer_load_dword v63, v5, s[32:35], s10 offen sc1
    s_waitcnt vmcnt(0)
    v_cmp_ne_u32 vcc, s12, v63
    s_cbranch_vccz lp1_ok
    s_sub_u32 s3, s3, 1
    s_cbranch_scc0 lp1
lp1_ok:
    s_add_u32 s14, s11, 4096
    buffer_load_dwordx4 v[96:99], v7, s[32:35], s11 offen offset:0 sc1
    buffer_load_dwordx4 v[100:103], v7, s[32:35], s11 offen offset:1024 sc1
    buffer_load_dwordx4 v[104:107], v7, s[32:35], s11 offen offset:2048 sc1
    buffer_load_dwordx4 v[108:111], v7, s[32:35], s11 offen offset:3072 sc1
    buffer_load_dwordx4 v[112:115], v7, s[32:35], s14 offen offset:0 sc1
    buffer_load_dwordx4 v[116:119], v7, s[32:35], s14 offen offset:1024 sc1
    buffer_load_dwordx4 v[120:123], v7, s[32:35], s14 offen offset:2048 sc1
    buffer_load_dwordx4 v[124:127], v7, s[32:35], s14 offen offset:3072 sc1
    s_add_u32 s11, s11, 196608
    s_add_u32 s10, s10, 128
    s_waitcnt lgkmcnt(0)
    v_sub_f32 v1, 1.0, v62
    v_cvt_pk_bf16_f32 v1, v1, v1
    v_lshlrev_b32 v1, 16, v1
    v_lshlrev_b32 v16, 16, v64
    v_and_b32 v17, 0xffff0000, v64
    v_lshlrev_b32 v18, 16, v65
    v_and_b32 v19, 0xffff0000, v65
    v_lshlrev_b32 v20, 16, v66
    v_and_b32 v21, 0xffff0000, v66
    v_lshlrev_b32 v22, 16, v67
    v_and_b32 v23, 0xffff0000, v67
    v_lshlrev_b32 v8, 16, v68
    v_and_b32 v9, 0xffff0000, v68
    v_lshlrev_b32 v10, 16, v69
    v_and_b32 v11, 0xffff0000, v69
    v_lshlrev_b32 v12, 16, v70
    v_and_b32 v13, 0xffff0000, v70
    v_lshlrev_b32 v14, 16, v71
    v_and_b32 v15, 0xffff0000, v71
    v_pk_add_f32 v[16:17], v[16:17], v[8:9]
    v_pk_add_f32 v[18:19], v[18:19], v[10:11]
    v_pk_add_f32 v[20:21], v[20:21], v[12:13]
    v_pk_add_f32 v[22:23], v[22:23], v[14:15]
    v_lshlrev_b32 v8, 16, v72
    v_and_b32 v9, 0xffff0000, v72
    v_lshlrev_b32 v10, 16, v73
    v_and_b32 v11, 0xffff0000, v73
    v_lshlrev_b32 v12, 16, v74
    v_and_b32 v13, 0xffff0000, v74
    v_lshlrev_b32 v14, 16, v75
    v_and_b32 v15, 0xffff0000, v75
    v_pk_add_f32 v[16:17], v[16:17], v[8:9]
    v_pk_add_f32 v[18:19], v[18:19], v[10:11]
    v_pk_add_f32 v[20:21], v[20:21], v[12:13]
    v_pk_add_f32 v[22:23], v[22:23], v[14:15]
    v_lshlrev_b32 v8, 16, v76
    v_and_b32 v9, 0xffff0000, v76
    v_lshlrev_b32 v10, 16, v77
    v_and_b32 v11, 0xffff0000, v77
    v_lshlrev_b32 v12, 16, v78
    v_and_b32 v13, 0xffff0000, v78
    v_lshlrev_b32 v14, 16, v79
    v_and_b32 v15, 0xffff0000, v79
    v_pk_add_f32 v[16:17], v[16:17], v[8:9]
    v_pk_add_f32 v[18:19], v[18:19], v[10:11]
    v_pk_add_f32 v[20:21], v[20:21], v[12:13]
    v_pk_add_f32 v[22:23], v[22:23], v[14:15]
    v_lshlrev_b32 v8, 16, v80
    v_and_b32 v9, 0xffff0000, v80
    v_lshlrev_b32 v10, 16, v81
    v_and_b32 v11, 0xffff0000, v81
    v_lshlrev_b32 v12, 16, v82
    v_and_b32 v13, 0xffff0000, v82
    v_lshlrev_b32 v14, 16, v83
    v_and_b32 v15, 0xffff0000, v83
    v_pk_add_f32 v[16:17], v[16:17], v[8:9]
    v_pk_add_f32 v[18:19], v[18:19], v[10:11]
    v_pk_add_f32 v[20:21], v[20:21], v[12:13]
    v_pk_add_f32 v[22:23], v[22:23], v[14:15]
    v_lshlrev_b32 v8, 16, v84
    v_and_b32 v9, 0xffff0000, v84
    v_lshlrev_b32 v10, 16, v85
    v_and_b32 v11, 0xffff0000, v85
    v_lshlrev_b32 v12, 16, v86
    v_and_b32 v13, 0xffff0000, v86
    v_lshlrev_b32 v14, 16, v87
    v_and_b32 v15, 0xffff0000, v87
    v_pk_add_f32 v[16:17], v[16:17], v[8:9]
    v_pk_add_f32 v[18:19], v[18:19], v[10:11]
    v_pk_add_f32 v[20:21], v[20:21], v[12:13]
    v_pk_add_f32 v[22:23], v[22:23], v[14:15]
    v_lshlrev_b32 v8, 16, v88
    v_and_b32 v9, 0xffff0000, v88
    v_lshlrev_b32 v10, 16, v89
    v_and_b32 v11, 0xffff0000, v89
    v_lshlrev_b32 v12, 16, v90
    v_and_b32 v13, 0xffff0000, v90
    v_lshlrev_b32 v14, 16, v91
    v_and_b32 v15, 0xffff0000, v91
    v_pk_add_f32 v[16:17], v[16:17], v[8:9]
    v_pk_add_f32 v[18:19], v[18:19], v[10:11]
    v_pk_add_f32 v[20:21], v[20:21], v[12:13]
    v_pk_add_f32 v[22:23], v[22:23], v[14:15]
    v_lshlrev_b32 v8, 16, v92
    v_and_b32 v9, 0xffff0000, v92
    v_lshlrev_b32 v10, 16, v93
    v_and_b32 v11, 0xffff0000, v93
    v_lshlrev_b32 v12, 16, v94
    v_and_b32 v13, 0xffff0000, v94
    v_lshlrev_b32 v14, 16, v95
    v_and_b32 v15, 0xffff0000, v95
    v_pk_add_f32 v[16:17], v[16:17], v[8:9]
    v_pk_add_f32 v[18:19], v[18:19], v[10:11]
    v_pk_add_f32 v[20:21], v[20:21], v[12:13]
    v_pk_add_f32 v[22:23], v[22:23], v[14:15]
    v_lshlrev_b32 v64, 16, v24
    v_and_b32 v65, 0xffff0000, v24
    v_lshlrev_b32 v66, 16, v25
    v_and_b32 v67, 0xffff0000, v25
    v_lshlrev_b32 v68, 16, v26
    v_and_b32 v69, 0xffff0000, v26
    v_lshlrev_b32 v70, 16, v27
    v_and_b32 v71, 0xffff0000, v27
    v_lshlrev_b32 v72, 16, v36
    v_and_b32 v73, 0xffff0000, v36
    v_lshlrev_b32 v74, 16, v37
    v_and_b32 v75, 0xffff0000, v37
    v_lshlrev_b32 v76, 16, v38
    v_and_b32 v77, 0xffff0000, v38
    v_lshlrev_b32 v78, 16, v39
    v_and_b32 v79, 0xffff0000, v39
    v_cvt_pk_bf16_f32 v8, v16, v17
    v_cvt_pk_bf16_f32 v9, v18, v19
    v_cvt_pk_bf16_f32 v10, v20, v21
    v_cvt_pk_bf16_f32 v11, v22, v23
    v_lshlrev_b32 v16, 16, v8
    v_and_b32 v17, 0xffff0000, v8
    v_lshlrev_b32 v18, 16, v9
    v_and_b32 v19, 0xffff0000, v9
    v_lshlrev_b32 v20, 16, v10
    v_and_b32 v21, 0xffff0000, v10
    v_lshlrev_b32 v22, 16, v11
    v_and_b32 v23, 0xffff0000, v11
    v_pk_add_f32 v[16:17], v[16:17], v[72:73]
    v_pk_add_f32 v[18:19], v[18:19], v[74:75]
    v_pk_add_f32 v[20:21], v[20:21], v[76:77]
    v_pk_add_f32 v[22:23], v[22:23], v[78:79]
    v_cvt_pk_bf16_f32 v8, v16, v17
    v_cvt_pk_bf16_f32 v9, v18, v19
    v_cvt_pk_bf16_f32 v10, v20, v21
    v_cvt_pk_bf16_f32 v11, v22, v23
    v_lshlrev_b32 v16, 16, v8
    v_and_b32 v17, 0xffff0000, v8
    v_lshlrev_b32 v18, 16, v9
    v_and_b32 v19, 0xffff0000, v9
    v_lshlrev_b32 v20, 16, v10
    v_and_b32 v21, 0xffff0000, v10
    v_lshlrev_b32 v22, 16, v11
    v_and_b32 v23, 0xffff0000, v11
    v_mul_f32 v16, v1, v16
    v_mul_f32 v17, v1, v17
    v_mul_f32 v18, v1, v18
    v_mul_f32 v19, v1, v19
    v_mul_f32 v20, v1, v20
    v_mul_f32 v21, v1, v21
    v_mul_f32 v22, v1, v22
    v_mul_f32 v23, v1, v23
    v_cvt_pk_bf16_f32 v8, v16, v17
    v_cvt_pk_bf16_f32 v9, v18, v19
    v_cvt_pk_bf16_f32 v10, v20, v21
    v_cvt_pk_bf16_f32 v11, v22, v23
    v_lshlrev_b32 v16, 16, v8
    v_and_b32 v17, 0xffff0000, v8
    v_lshlrev_b32 v18, 16, v9
    v_and_b32 v19, 0xffff0000, v9
    v_lshlrev_b32 v20, 16, v10
    v_and_b32 v21, 0xffff0000, v10
    v_lshlrev_b32 v22, 16, v11
    v_and_b32 v23, 0xffff0000, v11
    v_pk_add_f32 v[16:17], v[16:17], v[64:65]
    v_pk_add_f32 v[18:19], v[18:19], v[66:67]
    v_pk_add_f32 v[20:21], v[20:21], v[68:69]
    v_pk_add_f32 v[22:23], v[22:23], v[70:71]
    v_cvt_pk_bf16_f32 v80, v16, v17
    v_cvt_pk_bf16_f32 v81, v18, v19
    v_cvt_pk_bf16_f32 v82, v20, v21
    v_cvt_pk_bf16_f32 v83, v22, v23
    buffer_store_dwordx4 v[80:83], v3, s[52:55], s8 offen
    s_add_u32 s8, s8, 384
    v_lshlrev_b32 v64, 16, v28
    v_and_b32 v65, 0xffff0000, v28
    v_lshlrev_b32 v66, 16, v29
    v_and_b32 v67, 0xffff0000, v29
    v_lshlrev_b32 v68, 16, v30
    v_and_b32 v69, 0xffff0000, v30
    v_lshlrev_b32 v70, 16, v31
    v_and_b32 v71, 0xffff0000, v31
    v_lshlrev_b32 v72, 16, v40
    v_and_b32 v73, 0xffff0000, v40
    v_lshlrev_b32 v74, 16, v41
    v_and_b32 v75, 0xffff0000, v41
    v_lshlrev_b32 v76, 16, v42
    v_and_b32 v77, 0xffff0000, v42
    v_lshlrev_b32 v78, 16, v43
    v_and_b32 v79, 0xffff0000, v43
    s_mov_b32 s13, 0
k3_lt:
    s_waitcnt vmcnt(7)
    v_lshlrev_b32 v16, 16, v96
    v_and_b32 v17, 0xffff0000, v96
    v_lshlrev_b32 v18, 16, v97
    v_and_b32 v19, 0xffff0000, v97
    v_lshlrev_b32 v20, 16, v98
    v_and_b32 v21, 0xffff0000, v98
    v_lshlrev_b32 v22, 16, v99
    v_and_b32 v23, 0xffff0000, v99
    s_waitcnt vmcnt(6)
    v_lshlrev_b32 v8, 16, v100
    v_and_b32 v9, 0xffff0000, v100
    v_lshlrev_b32 v10, 16, v101
    v_and_b32 v11, 0xffff0000, v101
    v_lshlrev_b32 v12, 16, v102
    v_and_b32 v13, 0xffff0000, v102
    v_lshlrev_b32 v14, 16, v103
    v_and_b32 v15, 0xffff0000, v103
    v_pk_add_f32 v[16:17], v[16:17], v[8:9]
    v_pk_add_f32 v[18:19], v[18:19], v[10:11]
    v_pk_add_f32 v[20:21], v[20:21], v[12:13]
    v_pk_add_f32 v[22:23], v[22:23], v[14:15]
    s_waitcnt vmcnt(5)
    v_lshlrev_b32 v8, 16, v104
    v_and_b32 v9, 0xffff0000, v104
    v_lshlrev_b32 v10, 16, v105
    v_and_b32 v11, 0xffff0000, v105
    v_lshlrev_b32 v12, 16, v106
    v_and_b32 v13, 0xffff0000, v106
    v_lshlrev_b32 v14, 16, v107
    v_and_b32 v15, 0xffff0000, v107
    v_pk_add_f32 v[16:17], v[16:17], v[8:9]
    v_pk_add_f32 v[18:19], v[18:19], v[10:11]
    v_pk_add_f32 v[20:21], v[20:21], v[12:13]
    v_pk_add_f32 v[22:23], v[22:23], v[14:15]
    s_waitcnt vmcnt(4)
    v_lshlrev_b32 v8, 16, v108
    v_and_b32 v9, 0xffff0000, v108
    v_lshlrev_b32 v10, 16, v109
    v_and_b32 v11, 0xffff0000, v109
    v_lshlrev_b32 v12, 16, v110
    v_and_b32 v13, 0xffff0000, v110
    v_lshlrev_b32 v14, 16, v111
    v_and_b32 v15, 0xffff0000, v111
    v_pk_add_f32 v[16:17], v[16:17], v[8:9]
    v_pk_add_f32 v[18:19], v[18:19], v[10:11]
    v_pk_add_f32 v[20:21], v[20:21], v[12:13]
    v_pk_add_f32 v[22:23], v[22:23], v[14:15]
    s_waitcnt vmcnt(3)
    v_lshlrev_b32 v8, 16, v112
    v_and_b32 v9, 0xffff0000, v112
    v_lshlrev_b32 v10, 16, v113
    v_and_b32 v11, 0xffff0000, v113
    v_lshlrev_b32 v12, 16, v114
    v_and_b32 v13, 0xffff0000, v114
    v_lshlrev_b32 v14, 16, v115
    v_and_b32 v15, 0xffff0000, v115
    v_pk_add_f32 v[16:17], v[16:17], v[8:9]
    v_pk_add_f32 v[18:19], v[18:19], v[10:11]
    v_pk_add_f32 v[20:21], v[20:21], v[12:13]
    v_pk_add_f32 v[22:23], v[22:23], v[14:15]
    s_waitcnt vmcnt(2)
    v_lshlrev_b32 v8, 16, v116
    v_and_b32 v9, 0xffff0000, v116
    v_lshlrev_b32 v10, 16, v117
    v_and_b32 v11, 0xffff0000, v117
    v_lshlrev_b32 v12, 16, v118
    v_and_b32 v13, 0xffff0000, v118
    v_lshlrev_b32 v14, 16, v119
    v_and_b32 v15, 0xffff0000, v119
    v_pk_add_f32 v[16:17], v[16:17], v[8:9]
    v_pk_add_f32 v[18:19], v[18:19], v[10:11]
    v_pk_add_f32 v[20:21], v[20:21], v[12:13]
    v_pk_add_f32 v[22:23], v[22:23], v[14:15]
    s_waitcnt vmcnt(1)
    v_lshlrev_b32 v8, 16, v120
    v_and_b32 v9, 0xffff0000, v120
    v_lshlrev_b32 v10, 16, v121
    v_and_b32 v11, 0xffff0000, v121
    v_lshlrev_b32 v12, 16, v122
    v_and_b32 v13, 0xffff0000, v122
    v_lshlrev_b32 v14, 16, v123
    v_and_b32 v15, 0xffff0000, v123
    v_pk_add_f32 v[16:17], v[16:17], v[8:9]
    v_pk_add_f32 v[18:19], v[18:19], v[10:11]
    v_pk_add_f32 v[20:21], v[20:21], v[12:13]
    v_pk_add_f32 v[22:23], v[22:23], v[14:15]
    s_waitcnt vmcnt(0)
    v_lshlrev_b32 v8, 16, v124
    v_and_b32 v9, 0xffff0000, v124
    v_lshlrev_b32 v10, 16, v125
    v_and_b32 v11, 0xffff0000, v125
    v_lshlrev_b32 v12, 16, v126
    v_and_b32 v13, 0xffff0000, v126
    v_lshlrev_b32 v14, 16, v127
    v_and_b32 v15, 0xffff0000, v127
    v_pk_add_f32 v[16:17], v[16:17], v[8:9]
    v_pk_add_f32 v[18:19], v[18:19], v[10:11]
    v_pk_add_f32 v[20:21], v[20:21], v[12:13]
    v_pk_add_f32 v[22:23], v[22:23], v[14:15]
    v_cvt_pk_bf16_f32 v8, v16, v17
    v_cvt_pk_bf16_f32 v9, v18, v19
    v_cvt_pk_bf16_f32 v10, v20, v21
    v_cvt_pk_bf16_f32 v11, v22, v23
    v_lshlrev_b32 v16, 16, v8
    v_and_b32 v17, 0xffff0000, v8
    v_lshlrev_b32 v18, 16, v9
    v_and_b32 v19, 0xffff0000, v9
    v_lshlrev_b32 v20, 16, v10
    v_and_b32 v21, 0xffff0000, v10
    v_lshlrev_b32 v22, 16, v11
    v_and_b32 v23, 0xffff0000, v11
    v_pk_add_f32 v[16:17], v[16:17], v[72:73]
    v_pk_add_f32 v[18:19], v[18:19], v[74:75]
    v_pk_add_f32 v[20:21], v[20:21], v[76:77]
    v_pk_add_f32 v[22:23], v[22:23], v[78:79]
    v_cvt_pk_bf16_f32 v8, v16, v17
    v_cvt_pk_bf16_f32 v9, v18, v19
    v_cvt_pk_bf16_f32 v10, v20, v21
    v_cvt_pk_bf16_f32 v11, v22, v23
    v_lshlrev_b32 v16, 16, v8
    v_and_b32 v17, 0xffff0000, v8
    v_lshlrev_b32 v18, 16, v9
    v_and_b32 v19, 0xffff0000, v9
    v_lshlrev_b32 v20, 16, v10
    v_and_b32 v21, 0xffff0000, v10
    v_lshlrev_b32 v22, 16, v11
    v_and_b32 v23, 0xffff0000, v11
    v_mul_f32 v16, v1, v16
    v_mul_f32 v17, v1, v17
    v_mul_f32 v18, v1, v18
    v_mul_f32 v19, v1, v19
    v_mul_f32 v20, v1, v20
    v_mul_f32 v21, v1, v21
    v_mul_f32 v22, v1, v22
    v_mul_f32 v23, v1, v23
    v_cvt_pk_bf16_f32 v8, v16, v17
    v_cvt_pk_bf16_f32 v9, v18, v19
    v_cvt_pk_bf16_f32 v10, v20, v21
    v_cvt_pk_bf16_f32 v11, v22, v23
    v_lshlrev_b32 v16, 16, v8
    v_and_b32 v17, 0xffff0000, v8
    v_lshlrev_b32 v18, 16, v9
    v_and_b32 v19, 0xffff0000, v9
    v_lshlrev_b32 v20, 16, v10
    v_and_b32 v21, 0xffff0000, v10
    v_lshlrev_b32 v22, 16, v11
    v_and_b32 v23, 0xffff0000, v11
    v_pk_add_f32 v[16:17], v[16:17], v[64:65]
    v_pk_add_f32 v[18:19], v[18:19], v[66:67]
    v_pk_add_f32 v[20:21], v[20:21], v[68:69]
    v_pk_add_f32 v[22:23], v[22:23], v[70:71]
    v_cvt_pk_bf16_f32 v84, v16, v17
    v_cvt_pk_bf16_f32 v85, v18, v19
    v_cvt_pk_bf16_f32 v86, v20, v21
    v_cvt_pk_bf16_f32 v87, v22, v23
    buffer_store_dwordx4 v[84:87], v3, s[52:55], s8 offen
    s_add_u32 s8, s8, 384
    s_cmp_eq_u32 s13, 1
    s_cbranch_scc1 k3_done
    s_mov_b32 s13, 1
    v_lshlrev_b32 v64, 16, v32
    v_and_b32 v65, 0xffff0000, v32
    v_lshlrev_b32 v66, 16, v33
    v_and_b32 v67, 0xffff0000, v33
    v_lshlrev_b32 v68, 16, v34
    v_and_b32 v69, 0xffff0000, v34
    v_lshlrev_b32 v70, 16, v35
    v_and_b32 v71, 0xffff0000, v35
    v_lshlrev_b32 v72, 16, v44
    v_and_b32 v73, 0xffff0000, v44
    v_lshlrev_b32 v74, 16, v45
    v_and_b32 v75, 0xffff0000, v45
    v_lshlrev_b32 v76, 16, v46
    v_and_b32 v77, 0xffff0000, v46
    v_lshlrev_b32 v78, 16, v47
    v_and_b32 v79, 0xffff0000, v47
    v_mov_b32 v63, 0
    s_nop 0
    v_cmp_ne_u32 vcc, s12, v63
    s_cbranch_vccz lp2_ok
lp2:
    s_sleep 4
    buffer_load_dword v63, v5, s[32:35], s10 offen sc1
    s_waitcnt vmcnt(0)
    v_cmp_ne_u32 vcc, s12, v63
    s_cbranch_vccz lp2_ok
    s_sub_u32 s3, s3, 1
    s_cbranch_scc0 lp2
lp2_ok:
    s_add_u32 s14, s11, 4096
    buffer_load_dwordx4 v[96:99], v7, s[32:35], s11 offen offset:0 sc1
    buffer_load_dwordx4 v[100:103], v7, s[32:35], s11 offen offset:1024 sc1
    buffer_load_dwordx4 v[104:107], v7, s[32:35], s11 offen offset:2048 sc1
    buffer_load_dwordx4 v[108:111], v7, s[32:35], s11 offen offset:3072 sc1
    buffer_load_dwordx4 v[112:115], v7, s[32:35], s14 offen offset:0 sc1
    buffer_load_dwordx4 v[116:119], v7, s[32:35], s14 offen offset:1024 sc1
    buffer_load_dwordx4 v[120:123], v7, s[32:35], s14 offen offset:2048 sc1
    buffer_load_dwordx4 v[124:127], v7, s[32:35], s14 offen offset:3072 sc1
    s_add_u32 s11, s11, 196608
    s_add_u32 s10, s10, 128
    s_branch k3_lt
k3_comp:
    v_add_u32 v8, 0x10000, v7
    v_lshrrev_b32 v5, 2, v0
    v_mul_u32_u24 v5, 384, v5
    v_and_b32 v4, 3, v0
    v_lshl_add_u32 v5, v4, 3, v5
    v_add_u32 v5, 73728, v5
    v_bfe_u32 v4, v0, 3, 2
    v_xor_b32 v4, s59, v4
    v_lshl_add_u32 v1, v4, 5, v5
    s_mov_b32 s61, 0
    s_waitcnt lgkmcnt(0)

    s_add_u32 s28, s10, 7340032
    s_addc_u32 s29, s11, 0
    s_and_b32 s29, s29, 0xffff
    s_mov_b32 s30, 294912
    s_mov_b32 s31, 0x20000
    s_add_u32 s20, s10, 12189696
    s_addc_u32 s21, s11, 0
    s_and_b32 s21, s21, 0xffff
    s_mov_b32 s22, 13312
    s_mov_b32 s23, 0x20000
    s_cmp_lg_u32 s101, 12
    s_cbranch_scc1 m_poll_ok
    v_min_u32 v13, 17, v0
    v_cmp_lt_u32 vcc, 8, v13
    s_lshr_b32 s14, s57, 1
    s_lshl_b32 s14, s14, 8
    s_add_u32 s14, s14, 6400
    s_lshl_b32 s15, s56, 8
    s_add_u32 s15, s15, 10460
    v_mov_b32 v14, s14
    v_mov_b32 v15, s15
    v_cndmask_b32 v14, v14, v15, vcc
    v_lshl_add_u32 v13, v13, 2, v14

m_poll:
    buffer_load_dword v14, v13, s[20:23], 0 offen sc1
m_poll_chk:
    s_waitcnt vmcnt(0)
    v_cmp_ne_u32 vcc, 1, v14
    s_cbranch_vccz m_poll_ok
    s_sub_u32 s3, s3, 1
    s_cbranch_scc1 m_poll_ok
    s_sleep 4
    s_branch m_poll
m_poll_ok:
    s_barrier
    s_cmp_lg_u32 s58, 2
    s_cbranch_scc1 k3_ns
    s_lshl_b32 s14, s57, 2
    s_add_u32 s14, s14, s59
    s_lshl_b32 s14, s14, 4
    v_add_u32 v13, s14, v9
    v_lshlrev_b32 v13, 3, v13
    v_lshl_add_u32 v13, v10, 14, v13
    s_mov_b32 s14, 0x10000
    s_mov_b32 s15, 0x20000
    buffer_load_dwordx2 v[72:73], v13, s[28:31], 0 offen sc1
    buffer_load_dwordx2 v[74:75], v13, s[28:31], s14 offen sc1
    buffer_load_dwordx2 v[76:77], v13, s[28:31], s15 offen sc1
    s_mov_b32 s14, 0x30000
    s_mov_b32 s15, 0x40000
    buffer_load_dwordx2 v[78:79], v13, s[28:31], s14 offen sc1
    buffer_load_dwordx2 v[80:81], v13, s[28:31], s15 offen sc1
    k3_ns:

    s_add_u32 s24, s10, 2359296
    s_addc_u32 s25, s11, 0
    s_and_b32 s25, s25, 0xffff
    s_mov_b32 s26, 2359296
    s_mov_b32 s27, 0x20000
    s_add_u32 s32, s10, 12582912
    s_addc_u32 s33, s11, 0
    s_and_b32 s33, s33, 0xffff
    s_mov_b32 s34, 18874368
    s_mov_b32 s35, 0x20000
    s_add_u32 s36, s10, 33554432
    s_addc_u32 s37, s11, 0
    s_and_b32 s37, s37, 0xffff
    s_mov_b32 s38, 12288
    s_mov_b32 s39, 0x20000
    s_mov_b32 s40, s8
    s_and_b32 s41, s9, 0xffff
    s_mov_b32 s42, 2359296
    s_mov_b32 s43, 0x20000
    s_add_u32 s44, s10, 9437184
    s_addc_u32 s45, s11, 0
    s_and_b32 s45, s45, 0xffff
    s_mov_b32 s46, 2359296
    s_mov_b32 s47, 0x20000
    s_add_u32 s48, s10, 12058624
    s_addc_u32 s49, s11, 0
    s_and_b32 s49, s49, 0xffff
    s_mov_b32 s50, 8192
    s_mov_b32 s51, 0x20000
    s_mov_b32 s52, s12
    s_and_b32 s53, s13, 0xffff
    s_mov_b32 s54, 2359296
    s_mov_b32 s55, 0x20000
    s_mul_i32 s14, s56, 663552
    s_mul_i32 s15, s57, 20736
    s_add_u32 s14, s14, s15
    s_lshl_b32 s15, s59, 6
    s_add_u32 s14, s14, s15
    s_add_u32 s16, s6, s14
    s_addc_u32 s17, s7, 0

    s_cmp_eq_u32 s58, 1
    s_cbranch_scc1 k3_g1
    s_cmp_eq_u32 s58, 0
    s_cbranch_scc1 k3_g0
    v_add_u32 v120, 12288, v1
    v_add_u32 v121, 24576, v1
    v_add_u32 v122, 36864, v1
    v_add_u32 v123, 49152, v1
    v_add_u32 v124, 61440, v1
    v_add_u32 v125, 73728, v1
    v_add_u32 v126, 0, v1
    s_barrier
    s_barrier
    s_barrier
    s_barrier
    s_barrier
    s_waitcnt vmcnt(0)
    v_add_f32 v72, v72, v74
    v_add_f32 v73, v73, v75
    v_add_f32 v72, v72, v76
    v_add_f32 v73, v73, v77
    v_add_f32 v72, v72, v78
    v_add_f32 v73, v73, v79
    v_add_f32 v72, v72, v80
    v_add_f32 v73, v73, v81
    v_mov_b32 v14, v72
    s_nop 1
    v_permlane32_swap_b32 v72, v14
    s_nop 1
    v_add_f32 v72, v72, v14
    v_mov_b32 v14, v72
    s_nop 1
    v_permlane16_swap_b32 v72, v14
    s_nop 1
    v_add_f32 v72, v72, v14
    v_mov_b32 v14, v73
    s_nop 1
    v_permlane32_swap_b32 v73, v14
    s_nop 1
    v_add_f32 v73, v73, v14
    v_mov_b32 v14, v73
    s_nop 1
    v_permlane16_swap_b32 v73, v14
    s_nop 1
    v_add_f32 v73, v73, v14
    s_barrier
    v_mul_f32 v72, 0x3ae38e39, v72
    v_mul_f32 v73, 0x3ae38e39, v73
    v_fma_f32 v73, -v72, v72, v73
    v_max_f32 v73, 0, v73
    v_cvt_pk_bf16_f32 v84, v72, v72
    v_lshlrev_b32 v84, 16, v84
    v_xor_b32 v84, 0x80000000, v84
    v_cvt_pk_bf16_f32 v73, v73, v73
    v_lshlrev_b32 v73, 16, v73
    v_add_f32 v73, 0x3727c5ac, v73
    v_cvt_pk_bf16_f32 v73, v73, v73
    v_lshlrev_b32 v73, 16, v73
    v_sqrt_f32 v73, v73
    s_nop 0
    v_cvt_pk_bf16_f32 v87, v73, v73
    v_lshlrev_b32 v87, 16, v87
    v_rcp_f32 v14, v87
    s_nop 0
    v_mul_f32 v85, 0xc0135761, v14
    v_mul_f32 v86, v14, v14
    v_mul_f32 v86, v86, v85
    v_mul_f32 v86, 0x3d372713, v86
    s_lshl_b32 s14, s59, 8
    s_add_u32 s14, s14, 162816
    v_lshl_add_u32 v13, v9, 4, s14
    s_barrier
    s_mov_b64 exec, 0xffff
    ds_write_b128 v13, v[84:87]
    s_mov_b64 exec, -1
    s_barrier
    s_barrier
    s_waitcnt lgkmcnt(0)
    s_barrier
    s_barrier
    s_barrier
    s_barrier
    s_barrier
    s_barrier
    s_barrier
    s_barrier
    s_barrier
    s_barrier
    s_barrier
    s_barrier
    s_barrier
    s_barrier
    s_barrier
    s_barrier
    s_barrier
    s_barrier
    s_barrier
    s_barrier
    s_barrier
    s_barrier
    s_barrier
    s_barrier
    s_barrier
    s_barrier
    s_barrier
    s_barrier
    s_branch k3_body
k3_g1:
    v_add_u32 v120, 49152, v1
    v_add_u32 v121, 61440, v1
    v_add_u32 v122, 73728, v1
    v_add_u32 v123, 0, v1
    v_add_u32 v124, 12288, v1
    v_add_u32 v125, 24576, v1
    v_add_u32 v126, 36864, v1
    s_barrier
    s_barrier
    s_barrier
    s_barrier
    s_barrier
    s_barrier
    s_barrier
    s_barrier
    s_barrier
    s_barrier
    s_barrier
    s_barrier
    s_barrier
    s_barrier
    s_barrier
    s_barrier
    s_barrier
    s_barrier
    s_barrier
    s_branch k3_body
k3_g0:
    v_add_u32 v120, 0, v1
    v_add_u32 v121, 12288, v1
    v_add_u32 v122, 24576, v1
    v_add_u32 v123, 36864, v1
    v_add_u32 v124, 49152, v1
    v_add_u32 v125, 61440, v1
    v_add_u32 v126, 73728, v1
    s_barrier
k3_body:
    s_setprio 2
    ds_read_b128 v[16:19], v7 offset:0
    ds_read_b128 v[20:23], v7 offset:1024
    ds_read_b128 v[24:27], v7 offset:2048
    ds_read_b128 v[28:31], v7 offset:3072
    ds_read_b64_tr_b16 v[32:33], v120 offset:0
    ds_read_b64_tr_b16 v[34:35], v120 offset:6144
    ds_read_b64_tr_b16 v[36:37], v120 offset:128
    ds_read_b64_tr_b16 v[38:39], v120 offset:6272
    ds_read_b64_tr_b16 v[40:41], v120 offset:256
    ds_read_b64_tr_b16 v[42:43], v120 offset:6400
    s_barrier
    s_waitcnt lgkmcnt(4)
    v_mfma_f32_16x16x32_bf16 v[72:75], v[32:35], v[16:19], 0
    ds_read_b128 v[44:47], v7 offset:4096
    v_mfma_f32_16x16x32_bf16 v[76:79], v[32:35], v[20:23], 0
    ds_read_b128 v[48:51], v7 offset:5120
    v_mfma_f32_16x16x32_bf16 v[80:83], v[32:35], v[24:27], 0
    ds_read_b128 v[52:55], v7 offset:6144
    v_mfma_f32_16x16x32_bf16 v[84:87], v[32:35], v[28:31], 0
    ds_read_b128 v[56:59], v7 offset:7168
    s_waitcnt lgkmcnt(6)
    v_mfma_f32_16x16x32_bf16 v[100:103], v[36:39], v[28:31], 0
    ds_read_b64_tr_b16 v[60:61], v121 offset:0
    v_mfma_f32_16x16x32_bf16 v[96:99], v[36:39], v[24:27], 0
    ds_read_b64_tr_b16 v[62:63], v121 offset:6144
    v_mfma_f32_16x16x32_bf16 v[92:95], v[36:39], v[20:23], 0
    ds_read_b64_tr_b16 v[64:65], v121 offset:128
    v_mfma_f32_16x16x32_bf16 v[88:91], v[36:39], v[16:19], 0
    ds_read_b64_tr_b16 v[66:67], v121 offset:6272
    s_waitcnt lgkmcnt(8)
    v_mfma_f32_16x16x32_bf16 v[104:107], v[40:43], v[16:19], 0
    ds_read_b64_tr_b16 v[68:69], v121 offset:256
    v_mfma_f32_16x16x32_bf16 v[108:111], v[40:43], v[20:23], 0
    ds_read_b64_tr_b16 v[70:71], v121 offset:6400
    v_mfma_f32_16x16x32_bf16 v[112:115], v[40:43], v[24:27], 0
    v_mfma_f32_16x16x32_bf16 v[116:119], v[40:43], v[28:31], 0
    s_barrier
    s_waitcnt lgkmcnt(4)
    v_mfma_f32_16x16x32_bf16 v[72:75], v[60:63], v[44:47], v[72:75]
    ds_read_b128 v[16:19], v7 offset:8192
    v_mfma_f32_16x16x32_bf16 v[76:79], v[60:63], v[48:51], v[76:79]
    ds_read_b128 v[20:23], v7 offset:9216
    v_mfma_f32_16x16x32_bf16 v[80:83], v[60:63], v[52:55], v[80:83]
    ds_read_b128 v[24:27], v7 offset:10240
    v_mfma_f32_16x16x32_bf16 v[84:87], v[60:63], v[56:59], v[84:87]
    ds_read_b128 v[28:31], v7 offset:11264
    s_waitcnt lgkmcnt(6)
    v_mfma_f32_16x16x32_bf16 v[100:103], v[64:67], v[56:59], v[100:103]
    ds_read_b64_tr_b16 v[32:33], v122 offset:0
    v_mfma_f32_16x16x32_bf16 v[96:99], v[64:67], v[52:55], v[96:99]
    ds_read_b64_tr_b16 v[34:35], v122 offset:6144
    v_mfma_f32_16x16x32_bf16 v[92:95], v[64:67], v[48:51], v[92:95]
    ds_read_b64_tr_b16 v[36:37], v122 offset:128
    v_mfma_f32_16x16x32_bf16 v[88:91], v[64:67], v[44:47], v[88:91]
    ds_read_b64_tr_b16 v[38:39], v122 offset:6272
    s_waitcnt lgkmcnt(8)
    v_mfma_f32_16x16x32_bf16 v[104:107], v[68:71], v[44:47], v[104:107]
    ds_read_b64_tr_b16 v[40:41], v122 offset:256
    v_mfma_f32_16x16x32_bf16 v[108:111], v[68:71], v[48:51], v[108:111]
    ds_read_b64_tr_b16 v[42:43], v122 offset:6400
    v_mfma_f32_16x16x32_bf16 v[112:115], v[68:71], v[52:55], v[112:115]
    v_mfma_f32_16x16x32_bf16 v[116:119], v[68:71], v[56:59], v[116:119]
    s_barrier
    s_waitcnt lgkmcnt(4)
    v_mfma_f32_16x16x32_bf16 v[72:75], v[32:35], v[16:19], v[72:75]
    ds_read_b128 v[44:47], v7 offset:12288
    v_mfma_f32_16x16x32_bf16 v[76:79], v[32:35], v[20:23], v[76:79]
    ds_read_b128 v[48:51], v7 offset:13312
    v_mfma_f32_16x16x32_bf16 v[80:83], v[32:35], v[24:27], v[80:83]
    ds_read_b128 v[52:55], v7 offset:14336
    v_mfma_f32_16x16x32_bf16 v[84:87], v[32:35], v[28:31], v[84:87]
    ds_read_b128 v[56:59], v7 offset:15360
    s_waitcnt lgkmcnt(6)
    v_mfma_f32_16x16x32_bf16 v[100:103], v[36:39], v[28:31], v[100:103]
    ds_read_b64_tr_b16 v[60:61], v123 offset:0
    v_mfma_f32_16x16x32_bf16 v[96:99], v[36:39], v[24:27], v[96:99]
    ds_read_b64_tr_b16 v[62:63], v123 offset:6144
    v_mfma_f32_16x16x32_bf16 v[92:95], v[36:39], v[20:23], v[92:95]
    ds_read_b64_tr_b16 v[64:65], v123 offset:128
    v_mfma_f32_16x16x32_bf16 v[88:91], v[36:39], v[16:19], v[88:91]
    ds_read_b64_tr_b16 v[66:67], v123 offset:6272
    s_waitcnt lgkmcnt(8)
    v_mfma_f32_16x16x32_bf16 v[104:107], v[40:43], v[16:19], v[104:107]
    ds_read_b64_tr_b16 v[68:69], v123 offset:256
    v_mfma_f32_16x16x32_bf16 v[108:111], v[40:43], v[20:23], v[108:111]
    ds_read_b64_tr_b16 v[70:71], v123 offset:6400
    v_mfma_f32_16x16x32_bf16 v[112:115], v[40:43], v[24:27], v[112:115]
    v_mfma_f32_16x16x32_bf16 v[116:119], v[40:43], v[28:31], v[116:119]
    s_barrier
    s_waitcnt lgkmcnt(4)
    v_mfma_f32_16x16x32_bf16 v[72:75], v[60:63], v[44:47], v[72:75]
    ds_read_b128 v[16:19], v7 offset:16384
    v_mfma_f32_16x16x32_bf16 v[76:79], v[60:63], v[48:51], v[76:79]
    ds_read_b128 v[20:23], v7 offset:17408
    v_mfma_f32_16x16x32_bf16 v[80:83], v[60:63], v[52:55], v[80:83]
    ds_read_b128 v[24:27], v7 offset:18432
    v_mfma_f32_16x16x32_bf16 v[84:87], v[60:63], v[56:59], v[84:87]
    ds_read_b128 v[28:31], v7 offset:19456
    s_waitcnt lgkmcnt(6)
    v_mfma_f32_16x16x32_bf16 v[100:103], v[64:67], v[56:59], v[100:103]
    ds_read_b64_tr_b16 v[32:33], v124 offset:0
    v_mfma_f32_16x16x32_bf16 v[96:99], v[64:67], v[52:55], v[96:99]
    ds_read_b64_tr_b16 v[34:35], v124 offset:6144
    v_mfma_f32_16x16x32_bf16 v[92:95], v[64:67], v[48:51], v[92:95]
    ds_read_b64_tr_b16 v[36:37], v124 offset:128
    v_mfma_f32_16x16x32_bf16 v[88:91], v[64:67], v[44:47], v[88:91]
    ds_read_b64_tr_b16 v[38:39], v124 offset:6272
    s_waitcnt lgkmcnt(8)
    v_mfma_f32_16x16x32_bf16 v[104:107], v[68:71], v[44:47], v[104:107]
    ds_read_b64_tr_b16 v[40:41], v124 offset:256
    v_mfma_f32_16x16x32_bf16 v[108:111], v[68:71], v[48:51], v[108:111]
    ds_read_b64_tr_b16 v[42:43], v124 offset:6400
    v_mfma_f32_16x16x32_bf16 v[112:115], v[68:71], v[52:55], v[112:115]
    v_mfma_f32_16x16x32_bf16 v[116:119], v[68:71], v[56:59], v[116:119]
    s_barrier
    s_waitcnt lgkmcnt(4)
    v_mfma_f32_16x16x32_bf16 v[72:75], v[32:35], v[16:19], v[72:75]
    ds_read_b128 v[44:47], v7 offset:20480
    v_mfma_f32_16x16x32_bf16 v[76:79], v[32:35], v[20:23], v[76:79]
    ds_read_b128 v[48:51], v7 offset:21504
    v_mfma_f32_16x16x32_bf16 v[80:83], v[32:35], v[24:27], v[80:83]
    ds_read_b128 v[52:55], v7 offset:22528
    v_mfma_f32_16x16x32_bf16 v[84:87], v[32:35], v[28:31], v[84:87]
    ds_read_b128 v[56:59], v7 offset:23552
    s_waitcnt lgkmcnt(6)
    v_mfma_f32_16x16x32_bf16 v[100:103], v[36:39], v[28:31], v[100:103]
    ds_read_b64_tr_b16 v[60:61], v125 offset:0
    v_mfma_f32_16x16x32_bf16 v[96:99], v[36:39], v[24:27], v[96:99]
    ds_read_b64_tr_b16 v[62:63], v125 offset:6144
    v_mfma_f32_16x16x32_bf16 v[92:95], v[36:39], v[20:23], v[92:95]
    ds_read_b64_tr_b16 v[64:65], v125 offset:128
    v_mfma_f32_16x16x32_bf16 v[88:91], v[36:39], v[16:19], v[88:91]
    ds_read_b64_tr_b16 v[66:67], v125 offset:6272
    s_waitcnt lgkmcnt(8)
    v_mfma_f32_16x16x32_bf16 v[104:107], v[40:43], v[16:19], v[104:107]
    ds_read_b64_tr_b16 v[68:69], v125 offset:256
    v_mfma_f32_16x16x32_bf16 v[108:111], v[40:43], v[20:23], v[108:111]
    ds_read_b64_tr_b16 v[70:71], v125 offset:6400
    v_mfma_f32_16x16x32_bf16 v[112:115], v[40:43], v[24:27], v[112:115]
    v_mfma_f32_16x16x32_bf16 v[116:119], v[40:43], v[28:31], v[116:119]
    s_barrier
    s_waitcnt lgkmcnt(4)
    v_mfma_f32_16x16x32_bf16 v[72:75], v[60:63], v[44:47], v[72:75]
    ds_read_b128 v[16:19], v7 offset:24576
    v_mfma_f32_16x16x32_bf16 v[76:79], v[60:63], v[48:51], v[76:79]
    ds_read_b128 v[20:23], v7 offset:25600
    v_mfma_f32_16x16x32_bf16 v[80:83], v[60:63], v[52:55], v[80:83]
    ds_read_b128 v[24:27], v7 offset:26624
    v_mfma_f32_16x16x32_bf16 v[84:87], v[60:63], v[56:59], v[84:87]
    ds_read_b128 v[28:31], v7 offset:27648
    s_waitcnt lgkmcnt(6)
    v_mfma_f32_16x16x32_bf16 v[100:103], v[64:67], v[56:59], v[100:103]
    ds_read_b64_tr_b16 v[32:33], v126 offset:0
    v_mfma_f32_16x16x32_bf16 v[96:99], v[64:67], v[52:55], v[96:99]
    ds_read_b64_tr_b16 v[34:35], v126 offset:6144
    v_mfma_f32_16x16x32_bf16 v[92:95], v[64:67], v[48:51], v[92:95]
    ds_read_b64_tr_b16 v[36:37], v126 offset:128
    v_mfma_f32_16x16x32_bf16 v[88:91], v[64:67], v[44:47], v[88:91]
    ds_read_b64_tr_b16 v[38:39], v126 offset:6272
    s_waitcnt lgkmcnt(8)
    v_mfma_f32_16x16x32_bf16 v[104:107], v[68:71], v[44:47], v[104:107]
    ds_read_b64_tr_b16 v[40:41], v126 offset:256
    v_mfma_f32_16x16x32_bf16 v[108:111], v[68:71], v[48:51], v[108:111]
    ds_read_b64_tr_b16 v[42:43], v126 offset:6400
    v_mfma_f32_16x16x32_bf16 v[112:115], v[68:71], v[52:55], v[112:115]
    v_mfma_f32_16x16x32_bf16 v[116:119], v[68:71], v[56:59], v[116:119]
    s_barrier
    s_waitcnt lgkmcnt(4)
    v_mfma_f32_16x16x32_bf16 v[72:75], v[32:35], v[16:19], v[72:75]
    ds_read_b128 v[44:47], v7 offset:28672
    v_mfma_f32_16x16x32_bf16 v[76:79], v[32:35], v[20:23], v[76:79]
    ds_read_b128 v[48:51], v7 offset:29696
    v_mfma_f32_16x16x32_bf16 v[80:83], v[32:35], v[24:27], v[80:83]
    ds_read_b128 v[52:55], v7 offset:30720
    v_mfma_f32_16x16x32_bf16 v[84:87], v[32:35], v[28:31], v[84:87]
    ds_read_b128 v[56:59], v7 offset:31744
    s_waitcnt lgkmcnt(6)
    v_mfma_f32_16x16x32_bf16 v[100:103], v[36:39], v[28:31], v[100:103]
    ds_read_b64_tr_b16 v[60:61], v120 offset:0
    v_mfma_f32_16x16x32_bf16 v[96:99], v[36:39], v[24:27], v[96:99]
    ds_read_b64_tr_b16 v[62:63], v120 offset:6144
    v_mfma_f32_16x16x32_bf16 v[92:95], v[36:39], v[20:23], v[92:95]
    ds_read_b64_tr_b16 v[64:65], v120 offset:128
    v_mfma_f32_16x16x32_bf16 v[88:91], v[36:39], v[16:19], v[88:91]
    ds_read_b64_tr_b16 v[66:67], v120 offset:6272
    s_waitcnt lgkmcnt(8)
    v_mfma_f32_16x16x32_bf16 v[104:107], v[40:43], v[16:19], v[104:107]
    ds_read_b64_tr_b16 v[68:69], v120 offset:256
    v_mfma_f32_16x16x32_bf16 v[108:111], v[40:43], v[20:23], v[108:111]
    ds_read_b64_tr_b16 v[70:71], v120 offset:6400
    v_mfma_f32_16x16x32_bf16 v[112:115], v[40:43], v[24:27], v[112:115]
    v_mfma_f32_16x16x32_bf16 v[116:119], v[40:43], v[28:31], v[116:119]
    s_barrier
    s_waitcnt lgkmcnt(4)
    v_mfma_f32_16x16x32_bf16 v[72:75], v[60:63], v[44:47], v[72:75]
    ds_read_b128 v[16:19], v7 offset:32768
    v_mfma_f32_16x16x32_bf16 v[76:79], v[60:63], v[48:51], v[76:79]
    ds_read_b128 v[20:23], v7 offset:33792
    v_mfma_f32_16x16x32_bf16 v[80:83], v[60:63], v[52:55], v[80:83]
    ds_read_b128 v[24:27], v7 offset:34816
    v_mfma_f32_16x16x32_bf16 v[84:87], v[60:63], v[56:59], v[84:87]
    ds_read_b128 v[28:31], v7 offset:35840
    s_waitcnt lgkmcnt(6)
    v_mfma_f32_16x16x32_bf16 v[100:103], v[64:67], v[56:59], v[100:103]
    ds_read_b64_tr_b16 v[32:33], v121 offset:0
    v_mfma_f32_16x16x32_bf16 v[96:99], v[64:67], v[52:55], v[96:99]
    ds_read_b64_tr_b16 v[34:35], v121 offset:6144
    v_mfma_f32_16x16x32_bf16 v[92:95], v[64:67], v[48:51], v[92:95]
    ds_read_b64_tr_b16 v[36:37], v121 offset:128
    v_mfma_f32_16x16x32_bf16 v[88:91], v[64:67], v[44:47], v[88:91]
    ds_read_b64_tr_b16 v[38:39], v121 offset:6272
    s_waitcnt lgkmcnt(8)
    v_mfma_f32_16x16x32_bf16 v[104:107], v[68:71], v[44:47], v[104:107]
    ds_read_b64_tr_b16 v[40:41], v121 offset:256
    v_mfma_f32_16x16x32_bf16 v[108:111], v[68:71], v[48:51], v[108:111]
    ds_read_b64_tr_b16 v[42:43], v121 offset:6400
    v_mfma_f32_16x16x32_bf16 v[112:115], v[68:71], v[52:55], v[112:115]
    v_mfma_f32_16x16x32_bf16 v[116:119], v[68:71], v[56:59], v[116:119]
    s_barrier
    s_waitcnt lgkmcnt(4)
    v_mfma_f32_16x16x32_bf16 v[72:75], v[32:35], v[16:19], v[72:75]
    ds_read_b128 v[44:47], v7 offset:36864
    v_mfma_f32_16x16x32_bf16 v[76:79], v[32:35], v[20:23], v[76:79]
    ds_read_b128 v[48:51], v7 offset:37888
    v_mfma_f32_16x16x32_bf16 v[80:83], v[32:35], v[24:27], v[80:83]
    ds_read_b128 v[52:55], v7 offset:38912
    v_mfma_f32_16x16x32_bf16 v[84:87], v[32:35], v[28:31], v[84:87]
    ds_read_b128 v[56:59], v7 offset:39936
    s_waitcnt lgkmcnt(6)
    v_mfma_f32_16x16x32_bf16 v[100:103], v[36:39], v[28:31], v[100:103]
    ds_read_b64_tr_b16 v[60:61], v122 offset:0
    v_mfma_f32_16x16x32_bf16 v[96:99], v[36:39], v[24:27], v[96:99]
    ds_read_b64_tr_b16 v[62:63], v122 offset:6144
    v_mfma_f32_16x16x32_bf16 v[92:95], v[36:39], v[20:23], v[92:95]
    ds_read_b64_tr_b16 v[64:65], v122 offset:128
    v_mfma_f32_16x16x32_bf16 v[88:91], v[36:39], v[16:19], v[88:91]
    ds_read_b64_tr_b16 v[66:67], v122 offset:6272
    s_waitcnt lgkmcnt(8)
    v_mfma_f32_16x16x32_bf16 v[104:107], v[40:43], v[16:19], v[104:107]
    ds_read_b64_tr_b16 v[68:69], v122 offset:256
    v_mfma_f32_16x16x32_bf16 v[108:111], v[40:43], v[20:23], v[108:111]
    ds_read_b64_tr_b16 v[70:71], v122 offset:6400
    v_mfma_f32_16x16x32_bf16 v[112:115], v[40:43], v[24:27], v[112:115]
    v_mfma_f32_16x16x32_bf16 v[116:119], v[40:43], v[28:31], v[116:119]
    s_barrier
    s_waitcnt lgkmcnt(4)
    v_mfma_f32_16x16x32_bf16 v[72:75], v[60:63], v[44:47], v[72:75]
    ds_read_b128 v[16:19], v7 offset:40960
    v_mfma_f32_16x16x32_bf16 v[76:79], v[60:63], v[48:51], v[76:79]
    ds_read_b128 v[20:23], v7 offset:41984
    v_mfma_f32_16x16x32_bf16 v[80:83], v[60:63], v[52:55], v[80:83]
    ds_read_b128 v[24:27], v7 offset:43008
    v_mfma_f32_16x16x32_bf16 v[84:87], v[60:63], v[56:59], v[84:87]
    ds_read_b128 v[28:31], v7 offset:44032
    s_waitcnt lgkmcnt(6)
    v_mfma_f32_16x16x32_bf16 v[100:103], v[64:67], v[56:59], v[100:103]
    ds_read_b64_tr_b16 v[32:33], v123 offset:0
    v_mfma_f32_16x16x32_bf16 v[96:99], v[64:67], v[52:55], v[96:99]
    ds_read_b64_tr_b16 v[34:35], v123 offset:6144
    v_mfma_f32_16x16x32_bf16 v[92:95], v[64:67], v[48:51], v[92:95]
    ds_read_b64_tr_b16 v[36:37], v123 offset:128
    v_mfma_f32_16x16x32_bf16 v[88:91], v[64:67], v[44:47], v[88:91]
    ds_read_b64_tr_b16 v[38:39], v123 offset:6272
    s_waitcnt lgkmcnt(8)
    v_mfma_f32_16x16x32_bf16 v[104:107], v[68:71], v[44:47], v[104:107]
    ds_read_b64_tr_b16 v[40:41], v123 offset:256
    v_mfma_f32_16x16x32_bf16 v[108:111], v[68:71], v[48:51], v[108:111]
    ds_read_b64_tr_b16 v[42:43], v123 offset:6400
    v_mfma_f32_16x16x32_bf16 v[112:115], v[68:71], v[52:55], v[112:115]
    v_mfma_f32_16x16x32_bf16 v[116:119], v[68:71], v[56:59], v[116:119]
    s_barrier
    s_waitcnt lgkmcnt(4)
    v_mfma_f32_16x16x32_bf16 v[72:75], v[32:35], v[16:19], v[72:75]
    ds_read_b128 v[44:47], v7 offset:45056
    v_mfma_f32_16x16x32_bf16 v[76:79], v[32:35], v[20:23], v[76:79]
    ds_read_b128 v[48:51], v7 offset:46080
    v_mfma_f32_16x16x32_bf16 v[80:83], v[32:35], v[24:27], v[80:83]
    ds_read_b128 v[52:55], v7 offset:47104
    v_mfma_f32_16x16x32_bf16 v[84:87], v[32:35], v[28:31], v[84:87]
    ds_read_b128 v[56:59], v7 offset:48128
    s_waitcnt lgkmcnt(6)
    v_mfma_f32_16x16x32_bf16 v[100:103], v[36:39], v[28:31], v[100:103]
    ds_read_b64_tr_b16 v[60:61], v124 offset:0
    v_mfma_f32_16x16x32_bf16 v[96:99], v[36:39], v[24:27], v[96:99]
    ds_read_b64_tr_b16 v[62:63], v124 offset:6144
    v_mfma_f32_16x16x32_bf16 v[92:95], v[36:39], v[20:23], v[92:95]
    ds_read_b64_tr_b16 v[64:65], v124 offset:128
    v_mfma_f32_16x16x32_bf16 v[88:91], v[36:39], v[16:19], v[88:91]
    ds_read_b64_tr_b16 v[66:67], v124 offset:6272
    s_waitcnt lgkmcnt(8)
    v_mfma_f32_16x16x32_bf16 v[104:107], v[40:43], v[16:19], v[104:107]
    ds_read_b64_tr_b16 v[68:69], v124 offset:256
    v_mfma_f32_16x16x32_bf16 v[108:111], v[40:43], v[20:23], v[108:111]
    ds_read_b64_tr_b16 v[70:71], v124 offset:6400
    v_mfma_f32_16x16x32_bf16 v[112:115], v[40:43], v[24:27], v[112:115]
    v_mfma_f32_16x16x32_bf16 v[116:119], v[40:43], v[28:31], v[116:119]
    s_barrier
    s_waitcnt lgkmcnt(4)
    v_mfma_f32_16x16x32_bf16 v[72:75], v[60:63], v[44:47], v[72:75]
    ds_read_b128 v[16:19], v7 offset:49152
    v_mfma_f32_16x16x32_bf16 v[76:79], v[60:63], v[48:51], v[76:79]
    ds_read_b128 v[20:23], v7 offset:50176
    v_mfma_f32_16x16x32_bf16 v[80:83], v[60:63], v[52:55], v[80:83]
    ds_read_b128 v[24:27], v7 offset:51200
    v_mfma_f32_16x16x32_bf16 v[84:87], v[60:63], v[56:59], v[84:87]
    ds_read_b128 v[28:31], v7 offset:52224
    s_waitcnt lgkmcnt(6)
    v_mfma_f32_16x16x32_bf16 v[100:103], v[64:67], v[56:59], v[100:103]
    ds_read_b64_tr_b16 v[32:33], v125 offset:0
    v_mfma_f32_16x16x32_bf16 v[96:99], v[64:67], v[52:55], v[96:99]
    ds_read_b64_tr_b16 v[34:35], v125 offset:6144
    v_mfma_f32_16x16x32_bf16 v[92:95], v[64:67], v[48:51], v[92:95]
    ds_read_b64_tr_b16 v[36:37], v125 offset:128
    v_mfma_f32_16x16x32_bf16 v[88:91], v[64:67], v[44:47], v[88:91]
    ds_read_b64_tr_b16 v[38:39], v125 offset:6272
    s_waitcnt lgkmcnt(8)
    v_mfma_f32_16x16x32_bf16 v[104:107], v[68:71], v[44:47], v[104:107]
    ds_read_b64_tr_b16 v[40:41], v125 offset:256
    v_mfma_f32_16x16x32_bf16 v[108:111], v[68:71], v[48:51], v[108:111]
    ds_read_b64_tr_b16 v[42:43], v125 offset:6400
    v_mfma_f32_16x16x32_bf16 v[112:115], v[68:71], v[52:55], v[112:115]
    v_mfma_f32_16x16x32_bf16 v[116:119], v[68:71], v[56:59], v[116:119]
    s_barrier
    s_waitcnt lgkmcnt(4)
    v_mfma_f32_16x16x32_bf16 v[72:75], v[32:35], v[16:19], v[72:75]
    ds_read_b128 v[44:47], v7 offset:53248
    v_mfma_f32_16x16x32_bf16 v[76:79], v[32:35], v[20:23], v[76:79]
    ds_read_b128 v[48:51], v7 offset:54272
    v_mfma_f32_16x16x32_bf16 v[80:83], v[32:35], v[24:27], v[80:83]
    ds_read_b128 v[52:55], v7 offset:55296
    v_mfma_f32_16x16x32_bf16 v[84:87], v[32:35], v[28:31], v[84:87]
    ds_read_b128 v[56:59], v7 offset:56320
    s_waitcnt lgkmcnt(6)
    v_mfma_f32_16x16x32_bf16 v[100:103], v[36:39], v[28:31], v[100:103]
    ds_read_b64_tr_b16 v[60:61], v126 offset:0
    v_mfma_f32_16x16x32_bf16 v[96:99], v[36:39], v[24:27], v[96:99]
    ds_read_b64_tr_b16 v[62:63], v126 offset:6144
    v_mfma_f32_16x16x32_bf16 v[92:95], v[36:39], v[20:23], v[92:95]
    ds_read_b64_tr_b16 v[64:65], v126 offset:128
    v_mfma_f32_16x16x32_bf16 v[88:91], v[36:39], v[16:19], v[88:91]
    ds_read_b64_tr_b16 v[66:67], v126 offset:6272
    s_waitcnt lgkmcnt(8)
    v_mfma_f32_16x16x32_bf16 v[104:107], v[40:43], v[16:19], v[104:107]
    ds_read_b64_tr_b16 v[68:69], v126 offset:256
    v_mfma_f32_16x16x32_bf16 v[108:111], v[40:43], v[20:23], v[108:111]
    ds_read_b64_tr_b16 v[70:71], v126 offset:6400
    v_mfma_f32_16x16x32_bf16 v[112:115], v[40:43], v[24:27], v[112:115]
    s_cmp_eq_u32 s61, 2
    v_mfma_f32_16x16x32_bf16 v[116:119], v[40:43], v[28:31], v[116:119]
    s_barrier
    s_waitcnt lgkmcnt(4)
    v_mfma_f32_16x16x32_bf16 v[72:75], v[60:63], v[44:47], v[72:75]
    ds_read_b128 v[16:19], v7 offset:57344
    v_mfma_f32_16x16x32_bf16 v[76:79], v[60:63], v[48:51], v[76:79]
    ds_read_b128 v[20:23], v7 offset:58368
    v_mfma_f32_16x16x32_bf16 v[80:83], v[60:63], v[52:55], v[80:83]
    ds_read_b128 v[24:27], v7 offset:59392
    v_mfma_f32_16x16x32_bf16 v[84:87], v[60:63], v[56:59], v[84:87]
    ds_read_b128 v[28:31], v7 offset:60416
    s_waitcnt lgkmcnt(6)
    v_mfma_f32_16x16x32_bf16 v[100:103], v[64:67], v[56:59], v[100:103]
    ds_read_b64_tr_b16 v[32:33], v120 offset:0
    v_mfma_f32_16x16x32_bf16 v[96:99], v[64:67], v[52:55], v[96:99]
    ds_read_b64_tr_b16 v[34:35], v120 offset:6144
    v_mfma_f32_16x16x32_bf16 v[92:95], v[64:67], v[48:51], v[92:95]
    ds_read_b64_tr_b16 v[36:37], v120 offset:128
    v_mfma_f32_16x16x32_bf16 v[88:91], v[64:67], v[44:47], v[88:91]
    ds_read_b64_tr_b16 v[38:39], v120 offset:6272
    s_waitcnt lgkmcnt(8)
    v_mfma_f32_16x16x32_bf16 v[104:107], v[68:71], v[44:47], v[104:107]
    ds_read_b64_tr_b16 v[40:41], v120 offset:256
    v_mfma_f32_16x16x32_bf16 v[108:111], v[68:71], v[48:51], v[108:111]
    ds_read_b64_tr_b16 v[42:43], v120 offset:6400
    v_mfma_f32_16x16x32_bf16 v[112:115], v[68:71], v[52:55], v[112:115]
    v_mfma_f32_16x16x32_bf16 v[116:119], v[68:71], v[56:59], v[116:119]
    s_cbranch_scc1 k3_nb13
    s_barrier
k3_nb13:
    s_waitcnt lgkmcnt(4)
    v_mfma_f32_16x16x32_bf16 v[72:75], v[32:35], v[16:19], v[72:75]
    ds_read_b128 v[44:47], v7 offset:61440
    v_mfma_f32_16x16x32_bf16 v[76:79], v[32:35], v[20:23], v[76:79]
    ds_read_b128 v[48:51], v7 offset:62464
    v_mfma_f32_16x16x32_bf16 v[80:83], v[32:35], v[24:27], v[80:83]
    ds_read_b128 v[52:55], v7 offset:63488
    v_mfma_f32_16x16x32_bf16 v[84:87], v[32:35], v[28:31], v[84:87]
    ds_read_b128 v[56:59], v7 offset:64512
    s_waitcnt lgkmcnt(6)
    v_mfma_f32_16x16x32_bf16 v[100:103], v[36:39], v[28:31], v[100:103]
    ds_read_b64_tr_b16 v[60:61], v121 offset:0
    v_mfma_f32_16x16x32_bf16 v[96:99], v[36:39], v[24:27], v[96:99]
    ds_read_b64_tr_b16 v[62:63], v121 offset:6144
    v_mfma_f32_16x16x32_bf16 v[92:95], v[36:39], v[20:23], v[92:95]
    ds_read_b64_tr_b16 v[64:65], v121 offset:128
    v_mfma_f32_16x16x32_bf16 v[88:91], v[36:39], v[16:19], v[88:91]
    ds_read_b64_tr_b16 v[66:67], v121 offset:6272
    s_waitcnt lgkmcnt(8)
    v_mfma_f32_16x16x32_bf16 v[104:107], v[40:43], v[16:19], v[104:107]
    ds_read_b64_tr_b16 v[68:69], v121 offset:256
    v_mfma_f32_16x16x32_bf16 v[108:111], v[40:43], v[20:23], v[108:111]
    ds_read_b64_tr_b16 v[70:71], v121 offset:6400
    v_mfma_f32_16x16x32_bf16 v[112:115], v[40:43], v[24:27], v[112:115]
    v_mfma_f32_16x16x32_bf16 v[116:119], v[40:43], v[28:31], v[116:119]
    s_cbranch_scc1 k3_nb14
    s_barrier
k3_nb14:
    s_waitcnt lgkmcnt(4)
    v_mfma_f32_16x16x32_bf16 v[72:75], v[60:63], v[44:47], v[72:75]
    ds_read_b128 v[16:19], v8 offset:0
    v_mfma_f32_16x16x32_bf16 v[76:79], v[60:63], v[48:51], v[76:79]
    ds_read_b128 v[20:23], v8 offset:1024
    v_mfma_f32_16x16x32_bf16 v[80:83], v[60:63], v[52:55], v[80:83]
    ds_read_b128 v[24:27], v8 offset:2048
    v_mfma_f32_16x16x32_bf16 v[84:87], v[60:63], v[56:59], v[84:87]
    ds_read_b128 v[28:31], v8 offset:3072
    s_waitcnt lgkmcnt(6)
    v_mfma_f32_16x16x32_bf16 v[100:103], v[64:67], v[56:59], v[100:103]
    ds_read_b64_tr_b16 v[32:33], v122 offset:0
    v_mfma_f32_16x16x32_bf16 v[96:99], v[64:67], v[52:55], v[96:99]
    ds_read_b64_tr_b16 v[34:35], v122 offset:6144
    v_mfma_f32_16x16x32_bf16 v[92:95], v[64:67], v[48:51], v[92:95]
    ds_read_b64_tr_b16 v[36:37], v122 offset:128
    v_mfma_f32_16x16x32_bf16 v[88:91], v[64:67], v[44:47], v[88:91]
    ds_read_b64_tr_b16 v[38:39], v122 offset:6272
    s_waitcnt lgkmcnt(8)
    v_mfma_f32_16x16x32_bf16 v[104:107], v[68:71], v[44:47], v[104:107]
    ds_read_b64_tr_b16 v[40:41], v122 offset:256
    v_mfma_f32_16x16x32_bf16 v[108:111], v[68:71], v[48:51], v[108:111]
    ds_read_b64_tr_b16 v[42:43], v122 offset:6400
    v_mfma_f32_16x16x32_bf16 v[112:115], v[68:71], v[52:55], v[112:115]
    v_mfma_f32_16x16x32_bf16 v[116:119], v[68:71], v[56:59], v[116:119]
    s_cbranch_scc1 k3_nb15
    s_barrier
k3_nb15:
    s_waitcnt lgkmcnt(4)
    v_mfma_f32_16x16x32_bf16 v[72:75], v[32:35], v[16:19], v[72:75]
    ds_read_b128 v[44:47], v8 offset:4096
    v_mfma_f32_16x16x32_bf16 v[76:79], v[32:35], v[20:23], v[76:79]
    ds_read_b128 v[48:51], v8 offset:5120
    v_mfma_f32_16x16x32_bf16 v[80:83], v[32:35], v[24:27], v[80:83]
    ds_read_b128 v[52:55], v8 offset:6144
    v_mfma_f32_16x16x32_bf16 v[84:87], v[32:35], v[28:31], v[84:87]
    ds_read_b128 v[56:59], v8 offset:7168
    s_waitcnt lgkmcnt(6)
    v_mfma_f32_16x16x32_bf16 v[100:103], v[36:39], v[28:31], v[100:103]
    ds_read_b64_tr_b16 v[60:61], v123 offset:0
    v_mfma_f32_16x16x32_bf16 v[96:99], v[36:39], v[24:27], v[96:99]
    ds_read_b64_tr_b16 v[62:63], v123 offset:6144
    v_mfma_f32_16x16x32_bf16 v[92:95], v[36:39], v[20:23], v[92:95]
    ds_read_b64_tr_b16 v[64:65], v123 offset:128
    v_mfma_f32_16x16x32_bf16 v[88:91], v[36:39], v[16:19], v[88:91]
    ds_read_b64_tr_b16 v[66:67], v123 offset:6272
    s_waitcnt lgkmcnt(8)
    v_mfma_f32_16x16x32_bf16 v[104:107], v[40:43], v[16:19], v[104:107]
    ds_read_b64_tr_b16 v[68:69], v123 offset:256
    v_mfma_f32_16x16x32_bf16 v[108:111], v[40:43], v[20:23], v[108:111]
    ds_read_b64_tr_b16 v[70:71], v123 offset:6400
    v_mfma_f32_16x16x32_bf16 v[112:115], v[40:43], v[24:27], v[112:115]
    v_mfma_f32_16x16x32_bf16 v[116:119], v[40:43], v[28:31], v[116:119]
    s_cbranch_scc1 k3_nb16
    s_barrier
k3_nb16:
    s_waitcnt lgkmcnt(4)
    v_mfma_f32_16x16x32_bf16 v[72:75], v[60:63], v[44:47], v[72:75]
    v_mfma_f32_16x16x32_bf16 v[76:79], v[60:63], v[48:51], v[76:79]
    v_mfma_f32_16x16x32_bf16 v[80:83], v[60:63], v[52:55], v[80:83]
    v_mfma_f32_16x16x32_bf16 v[84:87], v[60:63], v[56:59], v[84:87]
    s_waitcnt lgkmcnt(2)
    v_mfma_f32_16x16x32_bf16 v[100:103], v[64:67], v[56:59], v[100:103]
    v_mfma_f32_16x16x32_bf16 v[96:99], v[64:67], v[52:55], v[96:99]
    v_mfma_f32_16x16x32_bf16 v[92:95], v[64:67], v[48:51], v[92:95]
    v_mfma_f32_16x16x32_bf16 v[88:91], v[64:67], v[44:47], v[88:91]
    s_waitcnt lgkmcnt(0)
    v_mfma_f32_16x16x32_bf16 v[104:107], v[68:71], v[44:47], v[104:107]
    v_mfma_f32_16x16x32_bf16 v[108:111], v[68:71], v[48:51], v[108:111]
    v_mfma_f32_16x16x32_bf16 v[112:115], v[68:71], v[52:55], v[112:115]
    v_mfma_f32_16x16x32_bf16 v[116:119], v[68:71], v[56:59], v[116:119]
    s_cbranch_scc1 k3_nb17
    s_barrier
k3_nb17:
    s_setprio 0
    s_cmp_ge_u32 s61, 1
    s_cbranch_scc1 k3_red
    s_mul_i32 s14, s58, 12
    s_add_u32 s14, s14, s59
    s_lshl_b32 s62, s14, 6
    s_add_u32 s62, s62, 159744
    v_lshl_add_u32 v4, v10, 4, s62
    v_lshlrev_b32 v3, 4, v9
    v_add_u32 v3, 162816, v3

    ds_read_b128 v[16:19], v3 offset:0
    ds_read_b128 v[20:23], v3 offset:256
    ds_read_b128 v[24:27], v3 offset:512
    ds_read_b128 v[28:31], v3 offset:768
    ds_read_b128 v[32:35], v4 offset:0
    ds_read_b128 v[36:39], v4 offset:256
    ds_read_b128 v[40:43], v4 offset:512
    s_mul_i32 s14, s58, 6
    s_add_u32 s15, s14, s59
    s_lshl_b32 s15, s15, 12
    v_add_u32 v5, s15, v7
    s_lshr_b32 s15, s59, 1
    s_add_u32 s15, s15, s14
    s_add_u32 s15, s15, 4
    s_lshl_b32 s15, s15, 12
    s_and_b32 s14, s59, 1
    s_lshl_b32 s14, s14, 3
    s_add_u32 s15, s15, s14
    v_add_u32 v6, s15, v7
    s_mov_b32 s61, 1

    s_cmp_eq_u32 s58, 1
    s_cbranch_scc1 k3_ge1

    s_cmp_eq_u32 s58, 2
    s_cbranch_scc1 k3_ge2

    s_barrier
    s_waitcnt lgkmcnt(0)
    v_fma_f32 v72, v16, v32, v72
    v_fma_f32 v73, v16, v33, v73
    v_fma_f32 v74, v16, v34, v74
    v_fma_f32 v75, v16, v35, v75
    v_fma_f32 v76, v20, v32, v76
    v_fma_f32 v77, v20, v33, v77
    v_fma_f32 v78, v20, v34, v78
    v_fma_f32 v79, v20, v35, v79
    v_mul_f32 v44, v72, v72
    v_mul_f32 v45, v73, v73
    v_mul_f32 v46, v74, v74
    v_mul_f32 v47, v75, v75
    v_mul_f32 v48, v76, v76
    v_mul_f32 v49, v77, v77
    v_mul_f32 v50, v78, v78
    v_mul_f32 v51, v79, v79
    v_fma_f32 v44, v44, v18, v17
    v_fma_f32 v45, v45, v18, v17
    v_fma_f32 v46, v46, v18, v17
    v_fma_f32 v47, v47, v18, v17
    v_fma_f32 v48, v48, v22, v21
    v_fma_f32 v49, v49, v22, v21
    v_fma_f32 v50, v50, v22, v21
    v_fma_f32 v51, v51, v22, v21
    v_mul_f32 v44, v72, v44
    v_mul_f32 v45, v73, v45
    v_mul_f32 v46, v74, v46
    v_mul_f32 v47, v75, v47
    s_barrier
    v_mul_f32 v48, v76, v48
    v_mul_f32 v49, v77, v49
    v_mul_f32 v50, v78, v50
    v_mul_f32 v51, v79, v51
    v_exp_f32 v44, v44
    v_exp_f32 v45, v45
    v_exp_f32 v46, v46
    v_exp_f32 v47, v47
    v_exp_f32 v48, v48
    v_exp_f32 v49, v49
    v_exp_f32 v50, v50
    v_exp_f32 v51, v51
    v_fma_f32 v44, v44, v19, v19
    v_fma_f32 v45, v45, v19, v19
    v_fma_f32 v46, v46, v19, v19
    v_fma_f32 v47, v47, v19, v19
    v_fma_f32 v48, v48, v23, v23
    v_fma_f32 v49, v49, v23, v23
    v_fma_f32 v50, v50, v23, v23
    v_fma_f32 v51, v51, v23, v23
    s_barrier
    v_rcp_f32 v44, v44
    v_rcp_f32 v45, v45
    v_rcp_f32 v46, v46
    v_rcp_f32 v47, v47
    v_rcp_f32 v48, v48
    v_rcp_f32 v49, v49
    v_rcp_f32 v50, v50
    v_rcp_f32 v51, v51
    v_mul_f32 v44, v72, v44
    v_mul_f32 v45, v73, v45
    v_mul_f32 v46, v74, v46
    v_mul_f32 v47, v75, v47
    v_mul_f32 v48, v76, v48
    v_mul_f32 v49, v77, v49
    v_mul_f32 v50, v78, v50
    v_mul_f32 v51, v79, v51
    v_cvt_pk_bf16_f32 v72, v44, v45
    v_cvt_pk_bf16_f32 v73, v46, v47
    v_cvt_pk_bf16_f32 v76, v48, v49
    v_cvt_pk_bf16_f32 v77, v50, v51
    s_barrier
    v_fma_f32 v80, v24, v32, v80
    v_fma_f32 v81, v24, v33, v81
    v_fma_f32 v82, v24, v34, v82
    v_fma_f32 v83, v24, v35, v83
    v_fma_f32 v84, v28, v32, v84
    v_fma_f32 v85, v28, v33, v85
    v_fma_f32 v86, v28, v34, v86
    v_fma_f32 v87, v28, v35, v87
    v_mul_f32 v44, v80, v80
    v_mul_f32 v45, v81, v81
    v_mul_f32 v46, v82, v82
    v_mul_f32 v47, v83, v83
    v_mul_f32 v48, v84, v84
    v_mul_f32 v49, v85, v85
    v_mul_f32 v50, v86, v86
    v_mul_f32 v51, v87, v87
    v_fma_f32 v44, v44, v26, v25
    v_fma_f32 v45, v45, v26, v25
    v_fma_f32 v46, v46, v26, v25
    v_fma_f32 v47, v47, v26, v25
    v_fma_f32 v48, v48, v30, v29
    v_fma_f32 v49, v49, v30, v29
    v_fma_f32 v50, v50, v30, v29
    v_fma_f32 v51, v51, v30, v29
    v_mul_f32 v44, v80, v44
    v_mul_f32 v45, v81, v45
    v_mul_f32 v46, v82, v46
    v_mul_f32 v47, v83, v47
    s_barrier
    v_mul_f32 v48, v84, v48
    v_mul_f32 v49, v85, v49
    v_mul_f32 v50, v86, v50
    v_mul_f32 v51, v87, v51
    v_exp_f32 v44, v44
    v_exp_f32 v45, v45
    v_exp_f32 v46, v46
    v_exp_f32 v47, v47
    v_exp_f32 v48, v48
    v_exp_f32 v49, v49
    v_exp_f32 v50, v50
    v_exp_f32 v51, v51
    v_fma_f32 v44, v44, v27, v27
    v_fma_f32 v45, v45, v27, v27
    v_fma_f32 v46, v46, v27, v27
    v_fma_f32 v47, v47, v27, v27
    v_fma_f32 v48, v48, v31, v31
    v_fma_f32 v49, v49, v31, v31
    v_fma_f32 v50, v50, v31, v31
    v_fma_f32 v51, v51, v31, v31
    s_barrier
    v_rcp_f32 v44, v44
    v_rcp_f32 v45, v45
    v_rcp_f32 v46, v46
    v_rcp_f32 v47, v47
    v_rcp_f32 v48, v48
    v_rcp_f32 v49, v49
    v_rcp_f32 v50, v50
    v_rcp_f32 v51, v51
    v_mul_f32 v44, v80, v44
    v_mul_f32 v45, v81, v45
    v_mul_f32 v46, v82, v46
    v_mul_f32 v47, v83, v47
    v_mul_f32 v48, v84, v48
    v_mul_f32 v49, v85, v49
    v_mul_f32 v50, v86, v50
    v_mul_f32 v51, v87, v51
    v_cvt_pk_bf16_f32 v80, v44, v45
    v_cvt_pk_bf16_f32 v81, v46, v47
    v_cvt_pk_bf16_f32 v84, v48, v49
    v_cvt_pk_bf16_f32 v85, v50, v51
    s_barrier
    v_fma_f32 v88, v16, v36, v88
    v_fma_f32 v89, v16, v37, v89
    v_fma_f32 v90, v16, v38, v90
    v_fma_f32 v91, v16, v39, v91
    v_fma_f32 v92, v20, v36, v92
    v_fma_f32 v93, v20, v37, v93
    v_fma_f32 v94, v20, v38, v94
    v_fma_f32 v95, v20, v39, v95
    v_mul_f32 v44, v88, v88
    v_mul_f32 v45, v89, v89
    v_mul_f32 v46, v90, v90
    v_mul_f32 v47, v91, v91
    v_mul_f32 v48, v92, v92
    v_mul_f32 v49, v93, v93
    v_mul_f32 v50, v94, v94
    v_mul_f32 v51, v95, v95
    v_fma_f32 v44, v44, v18, v17
    v_fma_f32 v45, v45, v18, v17
    v_fma_f32 v46, v46, v18, v17
    v_fma_f32 v47, v47, v18, v17
    v_fma_f32 v48, v48, v22, v21
    v_fma_f32 v49, v49, v22, v21
    v_fma_f32 v50, v50, v22, v21
    v_fma_f32 v51, v51, v22, v21
    v_mul_f32 v44, v88, v44
    v_mul_f32 v45, v89, v45
    v_mul_f32 v46, v90, v46
    v_mul_f32 v47, v91, v47
    s_barrier
    v_mul_f32 v48, v92, v48
    v_mul_f32 v49, v93, v49
    v_mul_f32 v50, v94, v50
    v_mul_f32 v51, v95, v51
    v_exp_f32 v44, v44
    v_exp_f32 v45, v45
    v_exp_f32 v46, v46
    v_exp_f32 v47, v47
    v_exp_f32 v48, v48
    v_exp_f32 v49, v49
    v_exp_f32 v50, v50
    v_exp_f32 v51, v51
    v_fma_f32 v44, v44, v19, v19
    v_fma_f32 v45, v45, v19, v19
    v_fma_f32 v46, v46, v19, v19
    v_fma_f32 v47, v47, v19, v19
    v_fma_f32 v48, v48, v23, v23
    v_fma_f32 v49, v49, v23, v23
    v_fma_f32 v50, v50, v23, v23
    v_fma_f32 v51, v51, v23, v23
    s_barrier
    v_rcp_f32 v44, v44
    v_rcp_f32 v45, v45
    v_rcp_f32 v46, v46
    v_rcp_f32 v47, v47
    v_rcp_f32 v48, v48
    v_rcp_f32 v49, v49
    v_rcp_f32 v50, v50
    v_rcp_f32 v51, v51
    v_mul_f32 v44, v88, v44
    v_mul_f32 v45, v89, v45
    v_mul_f32 v46, v90, v46
    v_mul_f32 v47, v91, v47
    v_mul_f32 v48, v92, v48
    v_mul_f32 v49, v93, v49
    v_mul_f32 v50, v94, v50
    v_mul_f32 v51, v95, v51
    v_cvt_pk_bf16_f32 v74, v44, v45
    v_cvt_pk_bf16_f32 v75, v46, v47
    v_cvt_pk_bf16_f32 v78, v48, v49
    v_cvt_pk_bf16_f32 v79, v50, v51
    s_barrier
    v_fma_f32 v96, v24, v36, v96
    v_fma_f32 v97, v24, v37, v97
    v_fma_f32 v98, v24, v38, v98
    v_fma_f32 v99, v24, v39, v99
    v_fma_f32 v100, v28, v36, v100
    v_fma_f32 v101, v28, v37, v101
    v_fma_f32 v102, v28, v38, v102
    v_fma_f32 v103, v28, v39, v103
    v_mul_f32 v44, v96, v96
    v_mul_f32 v45, v97, v97
    v_mul_f32 v46, v98, v98
    v_mul_f32 v47, v99, v99
    v_mul_f32 v48, v100, v100
    v_mul_f32 v49, v101, v101
    v_mul_f32 v50, v102, v102
    v_mul_f32 v51, v103, v103
    v_fma_f32 v44, v44, v26, v25
    v_fma_f32 v45, v45, v26, v25
    v_fma_f32 v46, v46, v26, v25
    v_fma_f32 v47, v47, v26, v25
    v_fma_f32 v48, v48, v30, v29
    v_fma_f32 v49, v49, v30, v29
    v_fma_f32 v50, v50, v30, v29
    v_fma_f32 v51, v51, v30, v29
    v_mul_f32 v44, v96, v44
    v_mul_f32 v45, v97, v45
    v_mul_f32 v46, v98, v46
    v_mul_f32 v47, v99, v47
    s_barrier
    v_mul_f32 v48, v100, v48
    v_mul_f32 v49, v101, v49
    v_mul_f32 v50, v102, v50
    v_mul_f32 v51, v103, v51
    v_exp_f32 v44, v44
    v_exp_f32 v45, v45
    v_exp_f32 v46, v46
    v_exp_f32 v47, v47
    v_exp_f32 v48, v48
    v_exp_f32 v49, v49
    v_exp_f32 v50, v50
    v_exp_f32 v51, v51
    v_fma_f32 v44, v44, v27, v27
    v_fma_f32 v45, v45, v27, v27
    v_fma_f32 v46, v46, v27, v27
    v_fma_f32 v47, v47, v27, v27
    v_fma_f32 v48, v48, v31, v31
    v_fma_f32 v49, v49, v31, v31
    v_fma_f32 v50, v50, v31, v31
    v_fma_f32 v51, v51, v31, v31
    s_barrier
    v_rcp_f32 v44, v44
    v_rcp_f32 v45, v45
    v_rcp_f32 v46, v46
    v_rcp_f32 v47, v47
    v_rcp_f32 v48, v48
    v_rcp_f32 v49, v49
    v_rcp_f32 v50, v50
    v_rcp_f32 v51, v51
    v_mul_f32 v44, v96, v44
    v_mul_f32 v45, v97, v45
    v_mul_f32 v46, v98, v46
    v_mul_f32 v47, v99, v47
    v_mul_f32 v48, v100, v48
    v_mul_f32 v49, v101, v49
    v_mul_f32 v50, v102, v50
    v_mul_f32 v51, v103, v51
    v_cvt_pk_bf16_f32 v82, v44, v45
    v_cvt_pk_bf16_f32 v83, v46, v47
    v_cvt_pk_bf16_f32 v86, v48, v49
    v_cvt_pk_bf16_f32 v87, v50, v51
    s_barrier
    v_fma_f32 v104, v16, v40, v104
    v_fma_f32 v105, v16, v41, v105
    v_fma_f32 v106, v16, v42, v106
    v_fma_f32 v107, v16, v43, v107
    v_fma_f32 v108, v20, v40, v108
    v_fma_f32 v109, v20, v41, v109
    v_fma_f32 v110, v20, v42, v110
    v_fma_f32 v111, v20, v43, v111
    v_mul_f32 v44, v104, v104
    v_mul_f32 v45, v105, v105
    v_mul_f32 v46, v106, v106
    v_mul_f32 v47, v107, v107
    v_mul_f32 v48, v108, v108
    v_mul_f32 v49, v109, v109
    v_mul_f32 v50, v110, v110
    v_mul_f32 v51, v111, v111
    v_fma_f32 v44, v44, v18, v17
    v_fma_f32 v45, v45, v18, v17
    v_fma_f32 v46, v46, v18, v17
    v_fma_f32 v47, v47, v18, v17
    v_fma_f32 v48, v48, v22, v21
    v_fma_f32 v49, v49, v22, v21
    v_fma_f32 v50, v50, v22, v21
    v_fma_f32 v51, v51, v22, v21
    v_mul_f32 v44, v104, v44
    v_mul_f32 v45, v105, v45
    v_mul_f32 v46, v106, v46
    v_mul_f32 v47, v107, v47
    s_barrier
    v_mul_f32 v48, v108, v48
    v_mul_f32 v49, v109, v49
    v_mul_f32 v50, v110, v50
    v_mul_f32 v51, v111, v51
    v_exp_f32 v44, v44
    v_exp_f32 v45, v45
    v_exp_f32 v46, v46
    v_exp_f32 v47, v47
    v_exp_f32 v48, v48
    v_exp_f32 v49, v49
    v_exp_f32 v50, v50
    v_exp_f32 v51, v51
    v_fma_f32 v44, v44, v19, v19
    v_fma_f32 v45, v45, v19, v19
    v_fma_f32 v46, v46, v19, v19
    v_fma_f32 v47, v47, v19, v19
    v_fma_f32 v48, v48, v23, v23
    v_fma_f32 v49, v49, v23, v23
    v_fma_f32 v50, v50, v23, v23
    v_fma_f32 v51, v51, v23, v23
    s_barrier
    v_rcp_f32 v44, v44
    v_rcp_f32 v45, v45
    v_rcp_f32 v46, v46
    v_rcp_f32 v47, v47
    v_rcp_f32 v48, v48
    v_rcp_f32 v49, v49
    v_rcp_f32 v50, v50
    v_rcp_f32 v51, v51
    v_mul_f32 v44, v104, v44
    v_mul_f32 v45, v105, v45
    v_mul_f32 v46, v106, v46
    v_mul_f32 v47, v107, v47
    v_mul_f32 v48, v108, v48
    v_mul_f32 v49, v109, v49
    v_mul_f32 v50, v110, v50
    v_mul_f32 v51, v111, v51
    v_cvt_pk_bf16_f32 v104, v44, v45
    v_cvt_pk_bf16_f32 v105, v46, v47
    v_cvt_pk_bf16_f32 v108, v48, v49
    v_cvt_pk_bf16_f32 v109, v50, v51
    s_barrier
    v_fma_f32 v112, v24, v40, v112
    v_fma_f32 v113, v24, v41, v113
    v_fma_f32 v114, v24, v42, v114
    v_fma_f32 v115, v24, v43, v115
    v_fma_f32 v116, v28, v40, v116
    v_fma_f32 v117, v28, v41, v117
    v_fma_f32 v118, v28, v42, v118
    v_fma_f32 v119, v28, v43, v119
    v_mul_f32 v44, v112, v112
    v_mul_f32 v45, v113, v113
    v_mul_f32 v46, v114, v114
    v_mul_f32 v47, v115, v115
    v_mul_f32 v48, v116, v116
    v_mul_f32 v49, v117, v117
    v_mul_f32 v50, v118, v118
    v_mul_f32 v51, v119, v119
    v_fma_f32 v44, v44, v26, v25
    v_fma_f32 v45, v45, v26, v25
    v_fma_f32 v46, v46, v26, v25
    v_fma_f32 v47, v47, v26, v25
    v_fma_f32 v48, v48, v30, v29
    v_fma_f32 v49, v49, v30, v29
    v_fma_f32 v50, v50, v30, v29
    v_fma_f32 v51, v51, v30, v29
    v_mul_f32 v44, v112, v44
    v_mul_f32 v45, v113, v45
    v_mul_f32 v46, v114, v46
    v_mul_f32 v47, v115, v47
    s_barrier
    v_mul_f32 v48, v116, v48
    v_mul_f32 v49, v117, v49
    v_mul_f32 v50, v118, v50
    v_mul_f32 v51, v119, v51
    v_exp_f32 v44, v44
    v_exp_f32 v45, v45
    v_exp_f32 v46, v46
    v_exp_f32 v47, v47
    v_exp_f32 v48, v48
    v_exp_f32 v49, v49
    v_exp_f32 v50, v50
    v_exp_f32 v51, v51
    v_fma_f32 v44, v44, v27, v27
    v_fma_f32 v45, v45, v27, v27
    v_fma_f32 v46, v46, v27, v27
    v_fma_f32 v47, v47, v27, v27
    v_fma_f32 v48, v48, v31, v31
    v_fma_f32 v49, v49, v31, v31
    v_fma_f32 v50, v50, v31, v31
    v_fma_f32 v51, v51, v31, v31
    s_barrier
    v_rcp_f32 v44, v44
    v_rcp_f32 v45, v45
    v_rcp_f32 v46, v46
    v_rcp_f32 v47, v47
    v_rcp_f32 v48, v48
    v_rcp_f32 v49, v49
    v_rcp_f32 v50, v50
    v_rcp_f32 v51, v51
    v_mul_f32 v44, v112, v44
    v_mul_f32 v45, v113, v45
    v_mul_f32 v46, v114, v46
    v_mul_f32 v47, v115, v47
    v_mul_f32 v48, v116, v48
    v_mul_f32 v49, v117, v49
    v_mul_f32 v50, v118, v50
    v_mul_f32 v51, v119, v51
    v_cvt_pk_bf16_f32 v112, v44, v45
    v_cvt_pk_bf16_f32 v113, v46, v47
    v_cvt_pk_bf16_f32 v116, v48, v49
    v_cvt_pk_bf16_f32 v117, v50, v51
    s_setprio 3
    s_barrier
    s_barrier
    s_barrier
    s_barrier
    s_barrier
    s_barrier
    s_barrier
    s_barrier
    s_barrier
    s_barrier
    s_barrier
    s_barrier
    s_barrier
    s_barrier
    s_barrier
    ds_write_b128 v5, v[72:75] offset:0
    ds_write_b128 v5, v[76:79] offset:1024
    ds_write_b128 v5, v[80:83] offset:2048
    ds_write_b128 v5, v[84:87] offset:3072
    ds_write_b64 v6, v[104:105] offset:0
    ds_write_b64 v6, v[108:109] offset:1024
    ds_write_b64 v6, v[112:113] offset:2048
    ds_write_b64 v6, v[116:117] offset:3072
    s_barrier
    s_setprio 0
    v_add_u32 v120, 61440, v1
    v_add_u32 v121, 73728, v1
    v_add_u32 v122, 0, v1
    v_add_u32 v123, 12288, v1
    v_add_u32 v124, 24576, v1
    v_add_u32 v125, 36864, v1
    v_add_u32 v126, 49152, v1
    s_waitcnt lgkmcnt(0)
    s_barrier
    s_branch k3_body
k3_ge1:
    s_barrier
    s_waitcnt lgkmcnt(0)
    v_fma_f32 v72, v16, v32, v72
    v_fma_f32 v73, v16, v33, v73
    v_fma_f32 v74, v16, v34, v74
    v_fma_f32 v75, v16, v35, v75
    v_fma_f32 v76, v20, v32, v76
    v_fma_f32 v77, v20, v33, v77
    v_fma_f32 v78, v20, v34, v78
    v_fma_f32 v79, v20, v35, v79
    v_mul_f32 v44, v72, v72
    v_mul_f32 v45, v73, v73
    v_mul_f32 v46, v74, v74
    v_mul_f32 v47, v75, v75
    v_mul_f32 v48, v76, v76
    v_mul_f32 v49, v77, v77
    v_mul_f32 v50, v78, v78
    v_mul_f32 v51, v79, v79
    v_fma_f32 v44, v44, v18, v17
    v_fma_f32 v45, v45, v18, v17
    v_fma_f32 v46, v46, v18, v17
    v_fma_f32 v47, v47, v18, v17
    v_fma_f32 v48, v48, v22, v21
    v_fma_f32 v49, v49, v22, v21
    v_fma_f32 v50, v50, v22, v21
    v_fma_f32 v51, v51, v22, v21
    v_mul_f32 v44, v72, v44
    v_mul_f32 v45, v73, v45
    v_mul_f32 v46, v74, v46
    v_mul_f32 v47, v75, v47
    v_mul_f32 v48, v76, v48
    v_mul_f32 v49, v77, v49
    v_mul_f32 v50, v78, v50
    v_mul_f32 v51, v79, v51
    v_exp_f32 v44, v44
    s_barrier
    v_exp_f32 v45, v45
    v_exp_f32 v46, v46
    v_exp_f32 v47, v47
    v_exp_f32 v48, v48
    v_exp_f32 v49, v49
    v_exp_f32 v50, v50
    v_exp_f32 v51, v51
    v_fma_f32 v44, v44, v19, v19
    v_fma_f32 v45, v45, v19, v19
    v_fma_f32 v46, v46, v19, v19
    v_fma_f32 v47, v47, v19, v19
    v_fma_f32 v48, v48, v23, v23
    v_fma_f32 v49, v49, v23, v23
    v_fma_f32 v50, v50, v23, v23
    v_fma_f32 v51, v51, v23, v23
    v_rcp_f32 v44, v44
    v_rcp_f32 v45, v45
    v_rcp_f32 v46, v46
    v_rcp_f32 v47, v47
    v_rcp_f32 v48, v48
    v_rcp_f32 v49, v49
    s_barrier
    v_rcp_f32 v50, v50
    v_rcp_f32 v51, v51
    v_mul_f32 v44, v72, v44
    v_mul_f32 v45, v73, v45
    v_mul_f32 v46, v74, v46
    v_mul_f32 v47, v75, v47
    v_mul_f32 v48, v76, v48
    v_mul_f32 v49, v77, v49
    v_mul_f32 v50, v78, v50
    v_mul_f32 v51, v79, v51
    v_cvt_pk_bf16_f32 v72, v44, v45
    v_cvt_pk_bf16_f32 v73, v46, v47
    v_cvt_pk_bf16_f32 v76, v48, v49
    v_cvt_pk_bf16_f32 v77, v50, v51
    v_fma_f32 v80, v24, v32, v80
    v_fma_f32 v81, v24, v33, v81
    v_fma_f32 v82, v24, v34, v82
    v_fma_f32 v83, v24, v35, v83
    v_fma_f32 v84, v28, v32, v84
    v_fma_f32 v85, v28, v33, v85
    v_fma_f32 v86, v28, v34, v86
    v_fma_f32 v87, v28, v35, v87
    v_mul_f32 v44, v80, v80
    v_mul_f32 v45, v81, v81
    v_mul_f32 v46, v82, v82
    v_mul_f32 v47, v83, v83
    v_mul_f32 v48, v84, v84
    v_mul_f32 v49, v85, v85
    v_mul_f32 v50, v86, v86
    v_mul_f32 v51, v87, v87
    v_fma_f32 v44, v44, v26, v25
    s_barrier
    v_fma_f32 v45, v45, v26, v25
    v_fma_f32 v46, v46, v26, v25
    v_fma_f32 v47, v47, v26, v25
    v_fma_f32 v48, v48, v30, v29
    v_fma_f32 v49, v49, v30, v29
    v_fma_f32 v50, v50, v30, v29
    v_fma_f32 v51, v51, v30, v29
    v_mul_f32 v44, v80, v44
    v_mul_f32 v45, v81, v45
    v_mul_f32 v46, v82, v46
    v_mul_f32 v47, v83, v47
    v_mul_f32 v48, v84, v48
    v_mul_f32 v49, v85, v49
    v_mul_f32 v50, v86, v50
    v_mul_f32 v51, v87, v51
    v_exp_f32 v44, v44
    v_exp_f32 v45, v45
    v_exp_f32 v46, v46
    v_exp_f32 v47, v47
    v_exp_f32 v48, v48
    v_exp_f32 v49, v49
    v_exp_f32 v50, v50
    v_exp_f32 v51, v51
    v_fma_f32 v44, v44, v27, v27
    v_fma_f32 v45, v45, v27, v27
    v_fma_f32 v46, v46, v27, v27
    s_barrier
    v_fma_f32 v47, v47, v27, v27
    v_fma_f32 v48, v48, v31, v31
    v_fma_f32 v49, v49, v31, v31
    v_fma_f32 v50, v50, v31, v31
    v_fma_f32 v51, v51, v31, v31
    v_rcp_f32 v44, v44
    v_rcp_f32 v45, v45
    v_rcp_f32 v46, v46
    v_rcp_f32 v47, v47
    v_rcp_f32 v48, v48
    v_rcp_f32 v49, v49
    v_rcp_f32 v50, v50
    v_rcp_f32 v51, v51
    v_mul_f32 v44, v80, v44
    v_mul_f32 v45, v81, v45
    v_mul_f32 v46, v82, v46
    v_mul_f32 v47, v83, v47
    v_mul_f32 v48, v84, v48
    v_mul_f32 v49, v85, v49
    v_mul_f32 v50, v86, v50
    v_mul_f32 v51, v87, v51
    v_cvt_pk_bf16_f32 v80, v44, v45
    v_cvt_pk_bf16_f32 v81, v46, v47
    v_cvt_pk_bf16_f32 v84, v48, v49
    v_cvt_pk_bf16_f32 v85, v50, v51
    s_barrier
    v_fma_f32 v88, v16, v36, v88
    v_fma_f32 v89, v16, v37, v89
    v_fma_f32 v90, v16, v38, v90
    v_fma_f32 v91, v16, v39, v91
    v_fma_f32 v92, v20, v36, v92
    v_fma_f32 v93, v20, v37, v93
    v_fma_f32 v94, v20, v38, v94
    v_fma_f32 v95, v20, v39, v95
    v_mul_f32 v44, v88, v88
    v_mul_f32 v45, v89, v89
    v_mul_f32 v46, v90, v90
    v_mul_f32 v47, v91, v91
    v_mul_f32 v48, v92, v92
    v_mul_f32 v49, v93, v93
    v_mul_f32 v50, v94, v94
    v_mul_f32 v51, v95, v95
    v_fma_f32 v44, v44, v18, v17
    v_fma_f32 v45, v45, v18, v17
    v_fma_f32 v46, v46, v18, v17
    v_fma_f32 v47, v47, v18, v17
    v_fma_f32 v48, v48, v22, v21
    v_fma_f32 v49, v49, v22, v21
    v_fma_f32 v50, v50, v22, v21
    v_fma_f32 v51, v51, v22, v21
    v_mul_f32 v44, v88, v44
    v_mul_f32 v45, v89, v45
    v_mul_f32 v46, v90, v46
    v_mul_f32 v47, v91, v47
    v_mul_f32 v48, v92, v48
    v_mul_f32 v49, v93, v49
    v_mul_f32 v50, v94, v50
    v_mul_f32 v51, v95, v51
    v_exp_f32 v44, v44
    s_barrier
    v_exp_f32 v45, v45
    v_exp_f32 v46, v46
    v_exp_f32 v47, v47
    v_exp_f32 v48, v48
    v_exp_f32 v49, v49
    v_exp_f32 v50, v50
    v_exp_f32 v51, v51
    v_fma_f32 v44, v44, v19, v19
    v_fma_f32 v45, v45, v19, v19
    v_fma_f32 v46, v46, v19, v19
    v_fma_f32 v47, v47, v19, v19
    v_fma_f32 v48, v48, v23, v23
    v_fma_f32 v49, v49, v23, v23
    v_fma_f32 v50, v50, v23, v23
    v_fma_f32 v51, v51, v23, v23
    v_rcp_f32 v44, v44
    v_rcp_f32 v45, v45
    v_rcp_f32 v46, v46
    v_rcp_f32 v47, v47
    v_rcp_f32 v48, v48
    v_rcp_f32 v49, v49
    s_barrier
    v_rcp_f32 v50, v50
    v_rcp_f32 v51, v51
    v_mul_f32 v44, v88, v44
    v_mul_f32 v45, v89, v45
    v_mul_f32 v46, v90, v46
    v_mul_f32 v47, v91, v47
    v_mul_f32 v48, v92, v48
    v_mul_f32 v49, v93, v49
    v_mul_f32 v50, v94, v50
    v_mul_f32 v51, v95, v51
    v_cvt_pk_bf16_f32 v74, v44, v45
    v_cvt_pk_bf16_f32 v75, v46, v47
    v_cvt_pk_bf16_f32 v78, v48, v49
    v_cvt_pk_bf16_f32 v79, v50, v51
    v_fma_f32 v96, v24, v36, v96
    v_fma_f32 v97, v24, v37, v97
    v_fma_f32 v98, v24, v38, v98
    v_fma_f32 v99, v24, v39, v99
    v_fma_f32 v100, v28, v36, v100
    v_fma_f32 v101, v28, v37, v101
    v_fma_f32 v102, v28, v38, v102
    v_fma_f32 v103, v28, v39, v103
    v_mul_f32 v44, v96, v96
    v_mul_f32 v45, v97, v97
    v_mul_f32 v46, v98, v98
    v_mul_f32 v47, v99, v99
    v_mul_f32 v48, v100, v100
    v_mul_f32 v49, v101, v101
    v_mul_f32 v50, v102, v102
    v_mul_f32 v51, v103, v103
    v_fma_f32 v44, v44, v26, v25
    s_barrier
    v_fma_f32 v45, v45, v26, v25
    v_fma_f32 v46, v46, v26, v25
    v_fma_f32 v47, v47, v26, v25
    v_fma_f32 v48, v48, v30, v29
    v_fma_f32 v49, v49, v30, v29
    v_fma_f32 v50, v50, v30, v29
    v_fma_f32 v51, v51, v30, v29
    v_mul_f32 v44, v96, v44
    v_mul_f32 v45, v97, v45
    v_mul_f32 v46, v98, v46
    v_mul_f32 v47, v99, v47
    v_mul_f32 v48, v100, v48
    v_mul_f32 v49, v101, v49
    v_mul_f32 v50, v102, v50
    v_mul_f32 v51, v103, v51
    v_exp_f32 v44, v44
    v_exp_f32 v45, v45
    v_exp_f32 v46, v46
    v_exp_f32 v47, v47
    v_exp_f32 v48, v48
    v_exp_f32 v49, v49
    v_exp_f32 v50, v50
    v_exp_f32 v51, v51
    v_fma_f32 v44, v44, v27, v27
    v_fma_f32 v45, v45, v27, v27
    v_fma_f32 v46, v46, v27, v27
    s_barrier
    v_fma_f32 v47, v47, v27, v27
    v_fma_f32 v48, v48, v31, v31
    v_fma_f32 v49, v49, v31, v31
    v_fma_f32 v50, v50, v31, v31
    v_fma_f32 v51, v51, v31, v31
    v_rcp_f32 v44, v44
    v_rcp_f32 v45, v45
    v_rcp_f32 v46, v46
    v_rcp_f32 v47, v47
    v_rcp_f32 v48, v48
    v_rcp_f32 v49, v49
    v_rcp_f32 v50, v50
    v_rcp_f32 v51, v51
    v_mul_f32 v44, v96, v44
    v_mul_f32 v45, v97, v45
    v_mul_f32 v46, v98, v46
    v_mul_f32 v47, v99, v47
    v_mul_f32 v48, v100, v48
    v_mul_f32 v49, v101, v49
    v_mul_f32 v50, v102, v50
    v_mul_f32 v51, v103, v51
    v_cvt_pk_bf16_f32 v82, v44, v45
    v_cvt_pk_bf16_f32 v83, v46, v47
    v_cvt_pk_bf16_f32 v86, v48, v49
    v_cvt_pk_bf16_f32 v87, v50, v51
    s_barrier
    v_fma_f32 v104, v16, v40, v104
    v_fma_f32 v105, v16, v41, v105
    v_fma_f32 v106, v16, v42, v106
    v_fma_f32 v107, v16, v43, v107
    v_fma_f32 v108, v20, v40, v108
    v_fma_f32 v109, v20, v41, v109
    v_fma_f32 v110, v20, v42, v110
    v_fma_f32 v111, v20, v43, v111
    v_mul_f32 v44, v104, v104
    v_mul_f32 v45, v105, v105
    v_mul_f32 v46, v106, v106
    v_mul_f32 v47, v107, v107
    v_mul_f32 v48, v108, v108
    v_mul_f32 v49, v109, v109
    v_mul_f32 v50, v110, v110
    v_mul_f32 v51, v111, v111
    v_fma_f32 v44, v44, v18, v17
    v_fma_f32 v45, v45, v18, v17
    v_fma_f32 v46, v46, v18, v17
    v_fma_f32 v47, v47, v18, v17
    v_fma_f32 v48, v48, v22, v21
    v_fma_f32 v49, v49, v22, v21
    v_fma_f32 v50, v50, v22, v21
    v_fma_f32 v51, v51, v22, v21
    v_mul_f32 v44, v104, v44
    v_mul_f32 v45, v105, v45
    v_mul_f32 v46, v106, v46
    v_mul_f32 v47, v107, v47
    v_mul_f32 v48, v108, v48
    v_mul_f32 v49, v109, v49
    v_mul_f32 v50, v110, v50
    v_mul_f32 v51, v111, v51
    v_exp_f32 v44, v44
    s_barrier
    v_exp_f32 v45, v45
    v_exp_f32 v46, v46
    v_exp_f32 v47, v47
    v_exp_f32 v48, v48
    v_exp_f32 v49, v49
    v_exp_f32 v50, v50
    v_exp_f32 v51, v51
    v_fma_f32 v44, v44, v19, v19
    v_fma_f32 v45, v45, v19, v19
    v_fma_f32 v46, v46, v19, v19
    v_fma_f32 v47, v47, v19, v19
    v_fma_f32 v48, v48, v23, v23
    v_fma_f32 v49, v49, v23, v23
    v_fma_f32 v50, v50, v23, v23
    v_fma_f32 v51, v51, v23, v23
    v_rcp_f32 v44, v44
    v_rcp_f32 v45, v45
    v_rcp_f32 v46, v46
    v_rcp_f32 v47, v47
    v_rcp_f32 v48, v48
    v_rcp_f32 v49, v49
    s_barrier
    v_rcp_f32 v50, v50
    v_rcp_f32 v51, v51
    v_mul_f32 v44, v104, v44
    v_mul_f32 v45, v105, v45
    v_mul_f32 v46, v106, v46
    v_mul_f32 v47, v107, v47
    v_mul_f32 v48, v108, v48
    v_mul_f32 v49, v109, v49
    v_mul_f32 v50, v110, v50
    v_mul_f32 v51, v111, v51
    v_cvt_pk_bf16_f32 v104, v44, v45
    v_cvt_pk_bf16_f32 v105, v46, v47
    v_cvt_pk_bf16_f32 v108, v48, v49
    v_cvt_pk_bf16_f32 v109, v50, v51
    v_fma_f32 v112, v24, v40, v112
    v_fma_f32 v113, v24, v41, v113
    v_fma_f32 v114, v24, v42, v114
    v_fma_f32 v115, v24, v43, v115
    v_fma_f32 v116, v28, v40, v116
    v_fma_f32 v117, v28, v41, v117
    v_fma_f32 v118, v28, v42, v118
    v_fma_f32 v119, v28, v43, v119
    v_mul_f32 v44, v112, v112
    v_mul_f32 v45, v113, v113
    v_mul_f32 v46, v114, v114
    v_mul_f32 v47, v115, v115
    v_mul_f32 v48, v116, v116
    v_mul_f32 v49, v117, v117
    v_mul_f32 v50, v118, v118
    v_mul_f32 v51, v119, v119
    v_fma_f32 v44, v44, v26, v25
    s_barrier
    v_fma_f32 v45, v45, v26, v25
    v_fma_f32 v46, v46, v26, v25
    v_fma_f32 v47, v47, v26, v25
    v_fma_f32 v48, v48, v30, v29
    v_fma_f32 v49, v49, v30, v29
    v_fma_f32 v50, v50, v30, v29
    v_fma_f32 v51, v51, v30, v29
    v_mul_f32 v44, v112, v44
    v_mul_f32 v45, v113, v45
    v_mul_f32 v46, v114, v46
    v_mul_f32 v47, v115, v47
    v_mul_f32 v48, v116, v48
    v_mul_f32 v49, v117, v49
    v_mul_f32 v50, v118, v50
    v_mul_f32 v51, v119, v51
    v_exp_f32 v44, v44
    v_exp_f32 v45, v45
    v_exp_f32 v46, v46
    v_exp_f32 v47, v47
    v_exp_f32 v48, v48
    v_exp_f32 v49, v49
    v_exp_f32 v50, v50
    v_exp_f32 v51, v51
    v_fma_f32 v44, v44, v27, v27
    v_fma_f32 v45, v45, v27, v27
    v_fma_f32 v46, v46, v27, v27
    s_barrier
    v_fma_f32 v47, v47, v27, v27
    v_fma_f32 v48, v48, v31, v31
    v_fma_f32 v49, v49, v31, v31
    v_fma_f32 v50, v50, v31, v31
    v_fma_f32 v51, v51, v31, v31
    v_rcp_f32 v44, v44
    v_rcp_f32 v45, v45
    v_rcp_f32 v46, v46
    v_rcp_f32 v47, v47
    v_rcp_f32 v48, v48
    v_rcp_f32 v49, v49
    v_rcp_f32 v50, v50
    v_rcp_f32 v51, v51
    v_mul_f32 v44, v112, v44
    v_mul_f32 v45, v113, v45
    v_mul_f32 v46, v114, v46
    v_mul_f32 v47, v115, v47
    v_mul_f32 v48, v116, v48
    v_mul_f32 v49, v117, v49
    v_mul_f32 v50, v118, v50
    v_mul_f32 v51, v119, v51
    v_cvt_pk_bf16_f32 v112, v44, v45
    v_cvt_pk_bf16_f32 v113, v46, v47
    v_cvt_pk_bf16_f32 v116, v48, v49
    v_cvt_pk_bf16_f32 v117, v50, v51
    s_setprio 3
    s_barrier
    ds_write_b128 v5, v[72:75] offset:0
    ds_write_b128 v5, v[76:79] offset:1024
    ds_write_b128 v5, v[80:83] offset:2048
    ds_write_b128 v5, v[84:87] offset:3072
    ds_write_b64 v6, v[104:105] offset:0
    ds_write_b64 v6, v[108:109] offset:1024
    ds_write_b64 v6, v[112:113] offset:2048
    ds_write_b64 v6, v[116:117] offset:3072
    s_barrier
    s_setprio 0
    v_add_u32 v120, 24576, v1
    v_add_u32 v121, 36864, v1
    v_add_u32 v122, 49152, v1
    v_add_u32 v123, 61440, v1
    v_add_u32 v124, 73728, v1
    v_add_u32 v125, 0, v1
    v_add_u32 v126, 12288, v1
    s_waitcnt lgkmcnt(0)
    s_barrier
    s_barrier
    s_barrier
    s_barrier
    s_barrier
    s_barrier
    s_barrier
    s_barrier
    s_barrier
    s_barrier
    s_barrier
    s_barrier
    s_barrier
    s_barrier
    s_barrier
    s_barrier
    s_barrier
    s_barrier
    s_branch k3_body
k3_ge2:
    s_barrier
    s_waitcnt lgkmcnt(0)
    v_fma_f32 v72, v16, v32, v72
    v_fma_f32 v73, v16, v33, v73
    v_fma_f32 v74, v16, v34, v74
    v_fma_f32 v75, v16, v35, v75
    v_fma_f32 v76, v20, v32, v76
    v_fma_f32 v77, v20, v33, v77
    v_fma_f32 v78, v20, v34, v78
    v_fma_f32 v79, v20, v35, v79
    v_mul_f32 v44, v72, v72
    v_mul_f32 v45, v73, v73
    v_mul_f32 v46, v74, v74
    v_mul_f32 v47, v75, v75
    v_mul_f32 v48, v76, v76
    v_mul_f32 v49, v77, v77
    v_mul_f32 v50, v78, v78
    v_mul_f32 v51, v79, v79
    v_fma_f32 v44, v44, v18, v17
    v_fma_f32 v45, v45, v18, v17
    v_fma_f32 v46, v46, v18, v17
    v_fma_f32 v47, v47, v18, v17
    v_fma_f32 v48, v48, v22, v21
    v_fma_f32 v49, v49, v22, v21
    v_fma_f32 v50, v50, v22, v21
    v_fma_f32 v51, v51, v22, v21
    v_mul_f32 v44, v72, v44
    v_mul_f32 v45, v73, v45
    v_mul_f32 v46, v74, v46
    v_mul_f32 v47, v75, v47
    v_mul_f32 v48, v76, v48
    v_mul_f32 v49, v77, v49
    v_mul_f32 v50, v78, v50
    v_mul_f32 v51, v79, v51
    v_exp_f32 v44, v44
    v_exp_f32 v45, v45
    v_exp_f32 v46, v46
    s_barrier
    v_exp_f32 v47, v47
    v_exp_f32 v48, v48
    v_exp_f32 v49, v49
    v_exp_f32 v50, v50
    v_exp_f32 v51, v51
    v_fma_f32 v44, v44, v19, v19
    v_fma_f32 v45, v45, v19, v19
    v_fma_f32 v46, v46, v19, v19
    v_fma_f32 v47, v47, v19, v19
    v_fma_f32 v48, v48, v23, v23
    v_fma_f32 v49, v49, v23, v23
    v_fma_f32 v50, v50, v23, v23
    v_fma_f32 v51, v51, v23, v23
    v_rcp_f32 v44, v44
    v_rcp_f32 v45, v45
    v_rcp_f32 v46, v46
    v_rcp_f32 v47, v47
    v_rcp_f32 v48, v48
    v_rcp_f32 v49, v49
    v_rcp_f32 v50, v50
    v_rcp_f32 v51, v51
    v_mul_f32 v44, v72, v44
    v_mul_f32 v45, v73, v45
    v_mul_f32 v46, v74, v46
    s_barrier
    v_mul_f32 v47, v75, v47
    v_mul_f32 v48, v76, v48
    v_mul_f32 v49, v77, v49
    v_mul_f32 v50, v78, v50
    v_mul_f32 v51, v79, v51
    v_cvt_pk_bf16_f32 v72, v44, v45
    v_cvt_pk_bf16_f32 v73, v46, v47
    v_cvt_pk_bf16_f32 v76, v48, v49
    v_cvt_pk_bf16_f32 v77, v50, v51
    v_fma_f32 v80, v24, v32, v80
    v_fma_f32 v81, v24, v33, v81
    v_fma_f32 v82, v24, v34, v82
    v_fma_f32 v83, v24, v35, v83
    v_fma_f32 v84, v28, v32, v84
    v_fma_f32 v85, v28, v33, v85
    v_fma_f32 v86, v28, v34, v86
    v_fma_f32 v87, v28, v35, v87
    v_mul_f32 v44, v80, v80
    v_mul_f32 v45, v81, v81
    v_mul_f32 v46, v82, v82
    v_mul_f32 v47, v83, v83
    v_mul_f32 v48, v84, v84
    v_mul_f32 v49, v85, v85
    v_mul_f32 v50, v86, v86
    v_mul_f32 v51, v87, v87
    v_fma_f32 v44, v44, v26, v25
    v_fma_f32 v45, v45, v26, v25
    v_fma_f32 v46, v46, v26, v25
    v_fma_f32 v47, v47, v26, v25
    v_fma_f32 v48, v48, v30, v29
    v_fma_f32 v49, v49, v30, v29
    v_fma_f32 v50, v50, v30, v29
    v_fma_f32 v51, v51, v30, v29
    v_mul_f32 v44, v80, v44
    v_mul_f32 v45, v81, v45
    v_mul_f32 v46, v82, v46
    v_mul_f32 v47, v83, v47
    s_barrier
    v_mul_f32 v48, v84, v48
    v_mul_f32 v49, v85, v49
    v_mul_f32 v50, v86, v50
    v_mul_f32 v51, v87, v51
    v_exp_f32 v44, v44
    v_exp_f32 v45, v45
    v_exp_f32 v46, v46
    v_exp_f32 v47, v47
    v_exp_f32 v48, v48
    v_exp_f32 v49, v49
    v_exp_f32 v50, v50
    v_exp_f32 v51, v51
    v_fma_f32 v44, v44, v27, v27
    v_fma_f32 v45, v45, v27, v27
    v_fma_f32 v46, v46, v27, v27
    v_fma_f32 v47, v47, v27, v27
    v_fma_f32 v48, v48, v31, v31
    v_fma_f32 v49, v49, v31, v31
    v_fma_f32 v50, v50, v31, v31
    v_fma_f32 v51, v51, v31, v31
    v_rcp_f32 v44, v44
    v_rcp_f32 v45, v45
    v_rcp_f32 v46, v46
    v_rcp_f32 v47, v47
    v_rcp_f32 v48, v48
    s_barrier
    v_rcp_f32 v49, v49
    v_rcp_f32 v50, v50
    v_rcp_f32 v51, v51
    v_mul_f32 v44, v80, v44
    v_mul_f32 v45, v81, v45
    v_mul_f32 v46, v82, v46
    v_mul_f32 v47, v83, v47
    v_mul_f32 v48, v84, v48
    v_mul_f32 v49, v85, v49
    v_mul_f32 v50, v86, v50
    v_mul_f32 v51, v87, v51
    v_cvt_pk_bf16_f32 v80, v44, v45
    v_cvt_pk_bf16_f32 v81, v46, v47
    v_cvt_pk_bf16_f32 v84, v48, v49
    v_cvt_pk_bf16_f32 v85, v50, v51
    v_fma_f32 v88, v16, v36, v88
    v_fma_f32 v89, v16, v37, v89
    v_fma_f32 v90, v16, v38, v90
    v_fma_f32 v91, v16, v39, v91
    v_fma_f32 v92, v20, v36, v92
    v_fma_f32 v93, v20, v37, v93
    v_fma_f32 v94, v20, v38, v94
    v_fma_f32 v95, v20, v39, v95
    v_mul_f32 v44, v88, v88
    v_mul_f32 v45, v89, v89
    v_mul_f32 v46, v90, v90
    v_mul_f32 v47, v91, v91
    v_mul_f32 v48, v92, v92
    v_mul_f32 v49, v93, v93
    v_mul_f32 v50, v94, v94
    v_mul_f32 v51, v95, v95
    v_fma_f32 v44, v44, v18, v17
    v_fma_f32 v45, v45, v18, v17
    v_fma_f32 v46, v46, v18, v17
    s_barrier
    v_fma_f32 v47, v47, v18, v17
    v_fma_f32 v48, v48, v22, v21
    v_fma_f32 v49, v49, v22, v21
    v_fma_f32 v50, v50, v22, v21
    v_fma_f32 v51, v51, v22, v21
    v_mul_f32 v44, v88, v44
    v_mul_f32 v45, v89, v45
    v_mul_f32 v46, v90, v46
    v_mul_f32 v47, v91, v47
    v_mul_f32 v48, v92, v48
    v_mul_f32 v49, v93, v49
    v_mul_f32 v50, v94, v50
    v_mul_f32 v51, v95, v51
    v_exp_f32 v44, v44
    v_exp_f32 v45, v45
    v_exp_f32 v46, v46
    v_exp_f32 v47, v47
    v_exp_f32 v48, v48
    v_exp_f32 v49, v49
    v_exp_f32 v50, v50
    v_exp_f32 v51, v51
    v_fma_f32 v44, v44, v19, v19
    v_fma_f32 v45, v45, v19, v19
    v_fma_f32 v46, v46, v19, v19
    v_fma_f32 v47, v47, v19, v19
    v_fma_f32 v48, v48, v23, v23
    v_fma_f32 v49, v49, v23, v23
    v_fma_f32 v50, v50, v23, v23
    v_fma_f32 v51, v51, v23, v23
    s_barrier
    v_rcp_f32 v44, v44
    v_rcp_f32 v45, v45
    v_rcp_f32 v46, v46
    v_rcp_f32 v47, v47
    v_rcp_f32 v48, v48
    v_rcp_f32 v49, v49
    v_rcp_f32 v50, v50
    v_rcp_f32 v51, v51
    v_mul_f32 v44, v88, v44
    v_mul_f32 v45, v89, v45
    v_mul_f32 v46, v90, v46
    v_mul_f32 v47, v91, v47
    v_mul_f32 v48, v92, v48
    v_mul_f32 v49, v93, v49
    v_mul_f32 v50, v94, v50
    v_mul_f32 v51, v95, v51
    v_cvt_pk_bf16_f32 v74, v44, v45
    v_cvt_pk_bf16_f32 v75, v46, v47
    v_cvt_pk_bf16_f32 v78, v48, v49
    v_cvt_pk_bf16_f32 v79, v50, v51
    v_fma_f32 v96, v24, v36, v96
    v_fma_f32 v97, v24, v37, v97
    v_fma_f32 v98, v24, v38, v98
    v_fma_f32 v99, v24, v39, v99
    v_fma_f32 v100, v28, v36, v100
    v_fma_f32 v101, v28, v37, v101
    v_fma_f32 v102, v28, v38, v102
    v_fma_f32 v103, v28, v39, v103
    v_mul_f32 v44, v96, v96
    v_mul_f32 v45, v97, v97
    s_barrier
    v_mul_f32 v46, v98, v98
    v_mul_f32 v47, v99, v99
    v_mul_f32 v48, v100, v100
    v_mul_f32 v49, v101, v101
    v_mul_f32 v50, v102, v102
    v_mul_f32 v51, v103, v103
    v_fma_f32 v44, v44, v26, v25
    v_fma_f32 v45, v45, v26, v25
    v_fma_f32 v46, v46, v26, v25
    v_fma_f32 v47, v47, v26, v25
    v_fma_f32 v48, v48, v30, v29
    v_fma_f32 v49, v49, v30, v29
    v_fma_f32 v50, v50, v30, v29
    v_fma_f32 v51, v51, v30, v29
    v_mul_f32 v44, v96, v44
    v_mul_f32 v45, v97, v45
    v_mul_f32 v46, v98, v46
    v_mul_f32 v47, v99, v47
    v_mul_f32 v48, v100, v48
    v_mul_f32 v49, v101, v49
    v_mul_f32 v50, v102, v50
    v_mul_f32 v51, v103, v51
    v_exp_f32 v44, v44
    v_exp_f32 v45, v45
    v_exp_f32 v46, v46
    v_exp_f32 v47, v47
    v_exp_f32 v48, v48
    v_exp_f32 v49, v49
    v_exp_f32 v50, v50
    v_exp_f32 v51, v51
    s_barrier
    v_fma_f32 v44, v44, v27, v27
    v_fma_f32 v45, v45, v27, v27
    v_fma_f32 v46, v46, v27, v27
    v_fma_f32 v47, v47, v27, v27
    v_fma_f32 v48, v48, v31, v31
    v_fma_f32 v49, v49, v31, v31
    v_fma_f32 v50, v50, v31, v31
    v_fma_f32 v51, v51, v31, v31
    v_rcp_f32 v44, v44
    v_rcp_f32 v45, v45
    v_rcp_f32 v46, v46
    v_rcp_f32 v47, v47
    v_rcp_f32 v48, v48
    v_rcp_f32 v49, v49
    v_rcp_f32 v50, v50
    v_rcp_f32 v51, v51
    v_mul_f32 v44, v96, v44
    v_mul_f32 v45, v97, v45
    v_mul_f32 v46, v98, v46
    v_mul_f32 v47, v99, v47
    v_mul_f32 v48, v100, v48
    v_mul_f32 v49, v101, v49
    v_mul_f32 v50, v102, v50
    v_mul_f32 v51, v103, v51
    v_cvt_pk_bf16_f32 v82, v44, v45
    v_cvt_pk_bf16_f32 v83, v46, v47
    v_cvt_pk_bf16_f32 v86, v48, v49
    v_cvt_pk_bf16_f32 v87, v50, v51
    s_setprio 3
    s_barrier
    ds_write_b128 v5, v[72:75] offset:0
    ds_write_b128 v5, v[76:79] offset:1024
    ds_write_b128 v5, v[80:83] offset:2048
    ds_write_b128 v5, v[84:87] offset:3072
    s_setprio 0
    v_fma_f32 v104, v16, v40, v104
    v_fma_f32 v105, v16, v41, v105
    v_fma_f32 v106, v16, v42, v106
    v_fma_f32 v107, v16, v43, v107
    v_fma_f32 v108, v20, v40, v108
    v_fma_f32 v109, v20, v41, v109
    v_fma_f32 v110, v20, v42, v110
    v_fma_f32 v111, v20, v43, v111
    s_waitcnt lgkmcnt(0)
    v_mul_f32 v44, v104, v104
    v_mul_f32 v45, v105, v105
    v_mul_f32 v46, v106, v106
    v_mul_f32 v47, v107, v107
    v_mul_f32 v48, v108, v108
    v_mul_f32 v49, v109, v109
    v_mul_f32 v50, v110, v110
    v_mul_f32 v51, v111, v111
    v_fma_f32 v44, v44, v18, v17
    v_fma_f32 v45, v45, v18, v17
    v_fma_f32 v46, v46, v18, v17
    v_fma_f32 v47, v47, v18, v17
    v_fma_f32 v48, v48, v22, v21
    v_fma_f32 v49, v49, v22, v21
    v_fma_f32 v50, v50, v22, v21
    v_fma_f32 v51, v51, v22, v21
    v_mul_f32 v44, v104, v44
    v_mul_f32 v45, v105, v45
    v_mul_f32 v46, v106, v46
    v_mul_f32 v47, v107, v47
    v_mul_f32 v48, v108, v48
    v_mul_f32 v49, v109, v49
    v_mul_f32 v50, v110, v50
    v_mul_f32 v51, v111, v51
    v_exp_f32 v44, v44
    v_exp_f32 v45, v45
    v_exp_f32 v46, v46
    v_exp_f32 v47, v47
    v_exp_f32 v48, v48
    s_barrier
    v_exp_f32 v49, v49
    v_exp_f32 v50, v50
    v_exp_f32 v51, v51
    v_fma_f32 v44, v44, v19, v19
    v_fma_f32 v45, v45, v19, v19
    v_fma_f32 v46, v46, v19, v19
    v_fma_f32 v47, v47, v19, v19
    v_fma_f32 v48, v48, v23, v23
    v_fma_f32 v49, v49, v23, v23
    v_fma_f32 v50, v50, v23, v23
    v_fma_f32 v51, v51, v23, v23
    v_rcp_f32 v44, v44
    v_rcp_f32 v45, v45
    v_rcp_f32 v46, v46
    v_rcp_f32 v47, v47
    v_rcp_f32 v48, v48
    v_rcp_f32 v49, v49
    v_rcp_f32 v50, v50
    v_rcp_f32 v51, v51
    v_mul_f32 v44, v104, v44
    v_mul_f32 v45, v105, v45
    v_mul_f32 v46, v106, v46
    v_mul_f32 v47, v107, v47
    v_mul_f32 v48, v108, v48
    v_mul_f32 v49, v109, v49
    v_mul_f32 v50, v110, v50
    v_mul_f32 v51, v111, v51
    v_cvt_pk_bf16_f32 v104, v44, v45
    v_cvt_pk_bf16_f32 v105, v46, v47
    v_cvt_pk_bf16_f32 v108, v48, v49
    v_cvt_pk_bf16_f32 v109, v50, v51
    s_barrier
    v_fma_f32 v112, v24, v40, v112
    v_fma_f32 v113, v24, v41, v113
    v_fma_f32 v114, v24, v42, v114
    v_fma_f32 v115, v24, v43, v115
    v_fma_f32 v116, v28, v40, v116
    v_fma_f32 v117, v28, v41, v117
    v_fma_f32 v118, v28, v42, v118
    v_fma_f32 v119, v28, v43, v119
    v_mul_f32 v44, v112, v112
    v_mul_f32 v45, v113, v113
    v_mul_f32 v46, v114, v114
    v_mul_f32 v47, v115, v115
    v_mul_f32 v48, v116, v116
    v_mul_f32 v49, v117, v117
    v_mul_f32 v50, v118, v118
    v_mul_f32 v51, v119, v119
    v_fma_f32 v44, v44, v26, v25
    v_fma_f32 v45, v45, v26, v25
    v_fma_f32 v46, v46, v26, v25
    v_fma_f32 v47, v47, v26, v25
    v_fma_f32 v48, v48, v30, v29
    v_fma_f32 v49, v49, v30, v29
    v_fma_f32 v50, v50, v30, v29
    v_fma_f32 v51, v51, v30, v29
    v_mul_f32 v44, v112, v44
    v_mul_f32 v45, v113, v45
    v_mul_f32 v46, v114, v46
    v_mul_f32 v47, v115, v47
    v_mul_f32 v48, v116, v48
    v_mul_f32 v49, v117, v49
    v_mul_f32 v50, v118, v50
    v_mul_f32 v51, v119, v51
    v_exp_f32 v44, v44
    v_exp_f32 v45, v45
    v_exp_f32 v46, v46
    v_exp_f32 v47, v47
    v_exp_f32 v48, v48
    s_barrier
    v_exp_f32 v49, v49
    v_exp_f32 v50, v50
    v_exp_f32 v51, v51
    v_fma_f32 v44, v44, v27, v27
    v_fma_f32 v45, v45, v27, v27
    v_fma_f32 v46, v46, v27, v27
    v_fma_f32 v47, v47, v27, v27
    v_fma_f32 v48, v48, v31, v31
    v_fma_f32 v49, v49, v31, v31
    v_fma_f32 v50, v50, v31, v31
    v_fma_f32 v51, v51, v31, v31
    v_rcp_f32 v44, v44
    v_rcp_f32 v45, v45
    v_rcp_f32 v46, v46
    v_rcp_f32 v47, v47
    v_rcp_f32 v48, v48
    v_rcp_f32 v49, v49
    v_rcp_f32 v50, v50
    v_rcp_f32 v51, v51
    v_mul_f32 v44, v112, v44
    v_mul_f32 v45, v113, v45
    v_mul_f32 v46, v114, v46
    v_mul_f32 v47, v115, v47
    v_mul_f32 v48, v116, v48
    v_mul_f32 v49, v117, v49
    v_mul_f32 v50, v118, v50
    v_mul_f32 v51, v119, v51
    v_cvt_pk_bf16_f32 v112, v44, v45
    v_cvt_pk_bf16_f32 v113, v46, v47
    v_cvt_pk_bf16_f32 v116, v48, v49
    v_cvt_pk_bf16_f32 v117, v50, v51
    s_setprio 3
    s_barrier
    s_mov_b32 s61, 2
    ds_write_b64 v6, v[104:105] offset:0
    ds_write_b64 v6, v[108:109] offset:1024
    ds_write_b64 v6, v[112:113] offset:2048
    ds_write_b64 v6, v[116:117] offset:3072
    s_setprio 0
    v_add_u32 v120, 73728, v1
    v_add_u32 v121, 0, v1
    v_add_u32 v122, 12288, v1
    v_add_u32 v123, 24576, v1
    v_add_u32 v124, 36864, v1
    v_add_u32 v125, 49152, v1
    v_add_u32 v126, 61440, v1
    s_waitcnt lgkmcnt(0)
    s_barrier
    s_barrier
    s_barrier
    s_barrier
    s_barrier
    s_barrier
    s_barrier
    s_barrier
    s_barrier
    s_barrier
    s_barrier
    s_barrier
    s_barrier
    s_barrier
    s_barrier
    s_barrier
    s_barrier
    s_barrier
    s_barrier
    s_barrier
    s_barrier
    s_branch k3_body
k3_red:
    s_mul_i32 s14, s57, 3
    s_add_u32 s14, s14, s58
    s_mul_i32 s15, s14, 24
    s_add_u32 s15, s15, s59
    s_lshl_b32 s15, s15, 3
    s_add_u32 s15, s15, s56
    s_lshl_b32 s15, s15, 10
    s_setprio 3

    v_cvt_pk_bf16_f32 v16, v72, v73
    v_cvt_pk_bf16_f32 v17, v74, v75
    v_cvt_pk_bf16_f32 v18, v76, v77
    v_cvt_pk_bf16_f32 v19, v78, v79
    v_cvt_pk_bf16_f32 v20, v80, v81
    v_cvt_pk_bf16_f32 v21, v82, v83
    v_cvt_pk_bf16_f32 v22, v84, v85
    v_cvt_pk_bf16_f32 v23, v86, v87
    v_permlane16_swap_b32 v16, v18
    v_permlane16_swap_b32 v17, v19
    buffer_store_dwordx4 v[16:19], v7, s[32:35], s15 offen sc1
    s_add_u32 s15, s15, 32768
    v_cvt_pk_bf16_f32 v24, v88, v89
    v_cvt_pk_bf16_f32 v25, v90, v91
    v_cvt_pk_bf16_f32 v26, v92, v93
    v_cvt_pk_bf16_f32 v27, v94, v95
    v_permlane16_swap_b32 v20, v22
    v_permlane16_swap_b32 v21, v23
    buffer_store_dwordx4 v[20:23], v7, s[32:35], s15 offen sc1
    s_add_u32 s15, s15, 32768
    v_cvt_pk_bf16_f32 v28, v96, v97
    v_cvt_pk_bf16_f32 v29, v98, v99
    v_cvt_pk_bf16_f32 v30, v100, v101
    v_cvt_pk_bf16_f32 v31, v102, v103
    v_permlane16_swap_b32 v24, v26
    v_permlane16_swap_b32 v25, v27
    buffer_store_dwordx4 v[24:27], v7, s[32:35], s15 offen sc1
    s_add_u32 s15, s15, 32768
    v_cvt_pk_bf16_f32 v32, v104, v105
    v_cvt_pk_bf16_f32 v33, v106, v107
    v_cvt_pk_bf16_f32 v34, v108, v109
    v_cvt_pk_bf16_f32 v35, v110, v111
    v_permlane16_swap_b32 v28, v30
    v_permlane16_swap_b32 v29, v31
    buffer_store_dwordx4 v[28:31], v7, s[32:35], s15 offen sc1
    s_add_u32 s15, s15, 32768
    v_cvt_pk_bf16_f32 v36, v112, v113
    v_cvt_pk_bf16_f32 v37, v114, v115
    v_cvt_pk_bf16_f32 v38, v116, v117
    v_cvt_pk_bf16_f32 v39, v118, v119
    v_permlane16_swap_b32 v32, v34
    v_permlane16_swap_b32 v33, v35
    buffer_store_dwordx4 v[32:35], v7, s[32:35], s15 offen sc1
    s_add_u32 s15, s15, 32768
    s_nop 1
    v_permlane16_swap_b32 v36, v38
    v_permlane16_swap_b32 v37, v39
    buffer_store_dwordx4 v[36:39], v7, s[32:35], s15 offen sc1
    s_add_u32 s15, s15, 32768
    s_setprio 0
    s_lshl_b32 s14, s14, 2
    s_add_u32 s14, s14, s59
    s_lshl_b32 s14, s14, 5
    s_lshl_b32 s63, s56, 2
    s_add_u32 s63, s63, s14
    v_mov_b32 v6, 0
    v_mov_b32 v15, 1

    s_cmp_eq_u32 s58, 2
    s_cbranch_scc1 k3_flag
    s_barrier
    s_barrier
    s_barrier
    s_barrier
    s_barrier
    s_barrier
    s_barrier
k3_flag:
    s_waitcnt vmcnt(0)
    s_mov_b64 exec, 1
    buffer_store_dword v15, v6, s[36:39], s63 offen sc1
    s_mov_b64 exec, -1
    s_cmp_eq_u32 s58, 2
    s_cbranch_scc1 k3_done
    s_barrier
    s_barrier
    s_barrier
    s_barrier
    s_barrier
    s_barrier
    s_branch k3_done_x
k3_done:
k3_done_x:
    s_endpgm
k3_end:
.section .rodata,"a"
.p2align 6
.amdhsa_kernel gated_mix__ssm_conv_h3__mixer_s_mlp__prompt_kernel
  .amdhsa_next_free_vgpr 128
  .amdhsa_next_free_sgpr 102
  .amdhsa_accum_offset 128
  .amdhsa_group_segment_fixed_size 0
  .amdhsa_kernarg_size 120
  .amdhsa_user_sgpr_count 2
  .amdhsa_user_sgpr_kernarg_segment_ptr 1
  .amdhsa_system_sgpr_workgroup_id_x 1
.end_amdhsa_kernel
```
